```python
import torch

def _softmax(x, axis=-1):
    return torch.softmax(x, dim=axis)
def _gelu(x):
    return torch.nn.functional.gelu(x, approximate="tanh")
def _silu(x):
    return torch.nn.functional.silu(x)
def _sigmoid(x):
    return torch.sigmoid(x)
def _layernorm(x, axis=-1, eps=1e-5):
    m = x.mean(dim=axis, keepdim=True)
    v = x.var(dim=axis, keepdim=True, unbiased=False)
    return (x - m) / torch.sqrt(v + eps)
def _scatter_add(tgt, idx, src, axis=0):
    return tgt.clone().index_add_(axis, idx, src)
def _segment_sum(src, seg, n):
    out = torch.zeros((n,) + src.shape[1:], dtype=src.dtype)
    return out.index_add_(0, seg, src)
def _pad(x, pw):
    flat = tuple(v for pair in reversed(pw) for v in pair)
    return torch.nn.functional.pad(x, flat)

kernel_name = 'interleave_layers__sliding_block_cached__dense_activation_silu__decode'

def setup_inputs():

    _w = (lambda a: (lambda t: t.to(torch.bfloat16) if t.is_floating_point() else t)(torch.as_tensor(a)))
    def _A_setup():
        B, Sq, D = 1, 1, 448
        Hq, Hkv, Sk, Dh = 16, 8, 65536, 256
        assert Hq % Hkv == 0, (Hq, Hkv)
        return {
            "x": _w((lambda *s: torch.randn(*s, dtype=torch.bfloat16) * 0.05)(B, Sq, D)),
            "k_cache": _w((lambda *s: torch.randn(*s, dtype=torch.bfloat16) * 0.8)(B, Hkv, Sk, Dh)),
            "v_cache": _w((lambda *s: torch.randn(*s, dtype=torch.bfloat16) * 1.6)(B, Hkv, Sk, Dh)),
            "wq": _w((lambda *s: torch.randn(*s, dtype=torch.bfloat16) * 0.8)(D, Hq * Dh) * (D ** -0.5)),
            "wo": _w((lambda *s: torch.randn(*s, dtype=torch.bfloat16) * 1.6)(Hq * Dh, D) * ((Hq * Dh) ** -0.5)),
        }
    _A_in = _A_setup()

    def _B_setup():
        B, S, D, F = 1, 1, 448, 1792
        return {
            "x": _w((lambda *s: torch.randn(*s, dtype=torch.bfloat16) * 0.05)(B, S, D)),
            "w1": _w((lambda *s: torch.randn(*s, dtype=torch.bfloat16) * 0.4)(D, F) * (D ** -0.5)),
            "w2": _w((lambda *s: torch.randn(*s, dtype=torch.bfloat16) * 0.4)(F, D) * (F ** -0.5)),
        }
    _B_in = _B_setup()

    return {
        "A_x": _A_in["x"],
        "A_k_cache": _A_in["k_cache"],
        "A_v_cache": _A_in["v_cache"],
        "A_wq": _A_in["wq"],
        "A_wo": _A_in["wo"],
        "B_x": _B_in["x"],
        "B_w1": _B_in["w1"],
        "B_w2": _B_in["w2"],
    }

def reference(A_x, A_k_cache, A_v_cache, A_wq, A_wo, B_x, B_w1, B_w2):
    def _A_ref(x, k_cache, v_cache, wq, wo):
        B, Sq, D = x.shape
        Hq, Dh = 16, 256
        Hkv, Sk = k_cache.shape[1], k_cache.shape[2]
        W = min(4096, max(256, Sk // 4))
        rep = Hq // Hkv
        q = (lambda x, *d: x.permute(*d))((x @ wq).reshape(B, Sq, Hq, Dh), 0, 2, 1, 3)
        k = (lambda x, n, axis: torch.repeat_interleave(x, n, dim=axis))(k_cache[:, :, Sk - W:, :], rep, axis=1)
        v = (lambda x, n, axis: torch.repeat_interleave(x, n, dim=axis))(v_cache[:, :, Sk - W:, :], rep, axis=1)
        scores = torch.einsum("bhqd,bhkd->bhqk", q, k) * (Dh ** -0.5)
        p = _softmax(scores, axis=-1)
        o = torch.einsum("bhqk,bhkd->bhqd", p, v)
        return (lambda x, *d: x.permute(*d))(o, 0, 2, 1, 3).reshape(B, Sq, Hq * Dh) @ wo

    def _B_ref(x, w1, w2):
        h = torch.einsum("bsd,df->bsf", x, w1)
        h = _silu(h)
        out = torch.einsum("bsf,fd->bsd", h, w2)
        return out

    x = A_x
    x = x + _A_ref(_layernorm(x, axis=-1), A_k_cache, A_v_cache, A_wq, A_wo)
    x = x + _B_ref(_layernorm(x, axis=-1), B_w1, B_w2)
    x = x + _A_ref(_layernorm(x, axis=-1), A_k_cache, A_v_cache, A_wq, A_wo)
    x = x + _B_ref(_layernorm(x, axis=-1), B_w1, B_w2)
    return x
```

```asm
; @launch grid=(256,1,1) block=(512,1,1) lds=146688
.amdgcn_target "amdgcn-amd-amdhsa--gfx950"
.text
.globl interleave_layers__sliding_block_cached__dense_activation_silu__decode_kernel
.p2align 12
.p2align 8
.type interleave_layers__sliding_block_cached__dense_activation_silu__decode_kernel,@function
interleave_layers__sliding_block_cached__dense_activation_silu__decode_kernel:
    s_load_dwordx16 s[8:23], s[0:1], 0
    s_load_dwordx2 s[24:25], s[0:1], 64
    s_load_dwordx2 s[28:29], s[0:1], 80
    s_cmp_ge_u32 s2, 256
    s_cbranch_scc1 L_exit
    s_lshr_b32 s5, s2, 3
    v_lshrrev_b32 v1, 6, v0
    v_and_b32 v0, 63, v0
    s_and_b32 s4, s2, 7
    v_readfirstlane_b32 s3, v1
    s_mov_b32 s35, 0x20000
    s_cmp_gt_u32 s3, 3
    s_cbranch_scc1 L_A
    v_lshrrev_b32 v18, 3, v0
    v_lshrrev_b32 v17, 4, v0
    v_bitop3_b32 v17, v17, v0, 2 bitop3:0x6c
    v_and_b32 v17, 7, v17
    v_lshlrev_b32 v17, 4, v17
    s_cmp_lg_u32 s3, 0
    s_cbranch_scc1 L_tch
    s_and_b32 s51, s5, 3
    s_mul_i32 s54, s51, 917472
    s_lshl_b32 s55, s4, 5
    s_add_u32 s55, s55, s5
    s_xor_b32 s55, s55, 16
    s_lshl_b32 s55, s55, 5
    s_add_u32 s54, s54, s55
    s_mov_b32 s34, 909440
    v_lshl_add_u32 v16, v18, 13, v17
    s_mov_b32 s47, 0
    s_mov_b32 s48, 65536
    s_mov_b32 s49, 1048576
    s_mov_b32 m0, 66560
    s_waitcnt lgkmcnt(0)
    s_add_u32 s32, s14, s54
    s_addc_u32 s33, s15, 0
L_wq:
    buffer_load_dwordx4 v16, s[32:35], s47 offen  lds
    s_add_u32 m0, m0, 1088
    s_add_u32 s47, s47, s48
    buffer_load_dwordx4 v16, s[32:35], s47 offen  lds
    s_add_u32 m0, m0, 1088
    s_add_u32 s47, s47, s48
    s_cmp_lt_u32 s47, s49
    s_cbranch_scc1 L_wq
    v_and_b32 v1, 15, v0
    v_lshrrev_b32 v2, 4, v0
    v_mul_u32_u24 v20, 14, v2
    v_cmp_gt_u32 vcc, 14, v1
    v_add_lshl_u32 v20, v20, v1, 4
    v_mov_b32 v19, 1073741824
    s_mov_b64 s[36:37], s[8:9]
    s_movk_i32 s38, 896
    s_mov_b32 s39, s35
    v_cndmask_b32 v3, v19, v20, vcc
    buffer_load_dwordx4 v[96:99], v3, s[36:39], 0 offen
    v_and_b32 v21, 1, v0
    v_lshl_add_u32 v20, v2, 2, v21
    v_lshlrev_b32 v20, 4, v20
    s_mul_i32 s51, s51, 224
    s_add_u32 s38, s51, 224
    buffer_load_dwordx4 v[128:131], v20, s[36:39], s51 offen
    buffer_load_dwordx4 v[132:135], v20, s[36:39], s51 offen offset:32
    s_mov_b32 s30, 3145728
    s_mov_b32 s31, s35
    s_mul_i32 s6, s4, 147456
    v_mov_b32 v28, 4289068965
    v_mov_b32 v29, v28
    s_lshr_b32 s54, s5, 4
    s_mul_i32 s54, s54, 65536
    s_lshl_b32 s55, s5, 9
    s_add_u32 s54, s54, s55
    s_add_u32 s54, s54, 327680
    v_lshl_add_u32 v21, v0, 3, s54
    buffer_store_dwordx2 v[28:29], v21, s[28:31], s6 offen sc1
    s_lshl_b32 s54, s4, 13
    s_lshl_b32 s55, s5, 8
    s_add_u32 s54, s54, s55
    s_add_u32 s54, s54, 1703936
    v_lshl_add_u32 v21, v0, 2, s54
    buffer_load_dword v230, v21, s[28:31], 0 offen sc1
L_wq2:
    s_barrier
    s_branch L_G
L_tch:
    s_cmp_lg_u32 s3, 1
    s_cbranch_scc1 Lc_2
    s_call_b64 s[88:89], PB0
Lc_2:
L_tch2:
    s_branch L_wq2
L_A:
    s_sub_u32 s3, s3, 4
    s_lshl_b32 s54, s4, 25
    s_lshl_b32 s55, s5, 16
    s_add_u32 s54, s54, s55
    s_add_u32 s54, s54, 31457280
    s_mov_b32 s55, 0
    s_bfe_u32 s56, s4, 0x10000
    s_lshl_b32 s56, s56, 12
    s_xor_b32 s55, s55, s56
    s_bfe_u32 s56, s4, 0x10002
    s_lshl_b32 s56, s56, 15
    s_xor_b32 s55, s55, s56
    s_xor_b32 s56, s55, 0
    s_xor_b32 s57, s55, 4096
    s_xor_b32 s58, s55, 32768
    s_xor_b32 s59, s55, 36864
    s_lshl_b32 s55, s3, 13
    v_lshl_add_u32 v3, v0, 4, s55
    s_mul_i32 s51, s3, 16640
    s_mov_b32 s34, 65536
    s_mov_b32 m0, s51
    s_waitcnt lgkmcnt(0)
    s_add_u32 s32, s10, s54
    s_addc_u32 s33, s11, 0
    s_load_dword s92, s[32:33], 2048
    s_load_dword s93, s[8:9], 0
    s_load_dword s94, s[28:29], 64
    s_add_u32 s36, s12, s54
    s_addc_u32 s37, s13, 0
    s_load_dword s95, s[36:37], 2048
    s_barrier
    buffer_load_dwordx4 v3, s[32:35], s56 offen offset:0 nt lds
    buffer_load_dwordx4 v3, s[32:35], s56 offen offset:1024 nt lds
    buffer_load_dwordx4 v3, s[32:35], s56 offen offset:2048 nt lds
    buffer_load_dwordx4 v3, s[32:35], s56 offen offset:3072 nt lds
    s_add_u32 m0, s51, 4160
    s_nop 0
    buffer_load_dwordx4 v3, s[32:35], s57 offen offset:0 nt lds
    buffer_load_dwordx4 v3, s[32:35], s57 offen offset:1024 nt lds
    buffer_load_dwordx4 v3, s[32:35], s57 offen offset:2048 nt lds
    s_mov_b32 s30, 3145728
    s_mov_b32 s31, 0x20000
    s_mul_i32 s6, s4, 147456
    s_add_u32 s6, s6, 262144
    s_mov_b32 s52, 4289068965
    s_mov_b32 s53, 0
    s_mov_b32 s26, 0
    s_mov_b32 s27, 0
    v_and_b32 v1, 15, v0
    v_lshrrev_b32 v2, 4, v0
    s_mov_b32 s38, s34
    s_mov_b32 s39, 0x20000
    s_add_u32 s36, s12, s54
    s_addc_u32 s37, s13, 0
    v_lshlrev_b32 v4, 9, v2
    v_lshl_add_u32 v4, v1, 4, v4
    v_add_u32 v4, s55, v4
    v_bfe_u32 v16, v1, 1, 1
    v_mul_u32_u24 v5, 0xaaaa, v16
    v_add_u32 v5, 0x4444, v5
    v_and_b32 v16, 3, v1
    v_mul_u32_u24 v6, 0x5555, v16
    v_mov_b32 v17, 0xffff
    v_lshrrev_b32 v16, 3, v1
    v_lshlrev_b32 v16, 4, v16
    v_lshlrev_b32 v17, v16, v17
    v_and_b32 v16, 4, v1
    v_cmp_eq_u32 vcc, 0, v16
    v_and_b32 v9, 3, v1
    v_lshlrev_b32 v9, 4, v9
    v_cndmask_b32 v7, 0, v17, vcc
    v_xor_b32 v8, v7, v17
    v_lshl_add_u32 v9, v2, 8, v9
    v_add_u32 v9, 144384, v9
    s_lshl_b32 s54, s3, 10
    s_add_u32 s54, s54, 136192
    v_lshl_add_u32 v11, v0, 4, s54
    s_lshl_b32 s54, s3, 8
    s_add_u32 s54, s54, 136192
    v_lshlrev_b32 v16, 10, v2
    v_lshl_add_u32 v16, v1, 4, v16
    v_add_u32 v12, s54, v16
    v_and_b32 v16, 32, v0
    v_add_u32 v16, 145408, v16
    s_lshl_b32 s54, s3, 3
    v_add_u32 v17, s54, v16
    v_and_b32 v16, 31, v0
    v_cmp_eq_u32 vcc, 0, v16
    v_lshlrev_b32 v16, 3, v0
    v_add_u32 v16, 145536, v16
    v_cndmask_b32 v13, v16, v17, vcc
    s_lshr_b32 s47, s3, 1
    s_lshl_b32 s54, s47, 15
    s_lshl_b32 s40, s5, 6
    s_add_u32 s54, s54, s40
    s_and_b32 s40, s3, 1
    s_lshl_b32 s40, s40, 4
    s_add_u32 s54, s54, s40
    v_lshrrev_b32 v16, 1, v0
    v_lshlrev_b32 v16, 11, v16
    v_and_b32 v17, 1, v0
    v_lshl_add_u32 v16, v17, 5, v16
    v_cmp_gt_u32 vcc, 32, v0
    v_add_u32 v16, s54, v16
    v_mov_b32 v18, 1073741824
    v_cndmask_b32 v15, v18, v16, vcc
    s_lshl_b32 s47, s47, 5
    s_add_u32 s47, s47, 145408
    v_and_b32 v16, 3, v0
    v_lshl_add_u32 v14, v16, 3, s47
    v_lshl_add_u32 v10, v2, 3, s47
    v_lshlrev_b32 v17, 4, v17
    v_mov_b32 v16, 0xffff
    v_lshlrev_b32 v16, v17, v16
    v_bfe_u32 v17, v1, 1, 2
    v_cmp_eq_u32 vcc, 0, v17
    v_cmp_eq_u32 s[40:41], 1, v17
    v_cmp_eq_u32 s[42:43], 2, v17
    v_cmp_eq_u32 s[44:45], 3, v17
    v_cndmask_b32 v24, 0, v16, vcc
    v_cndmask_b32 v25, 0, v16, s[40:41]
    v_cndmask_b32 v26, 0, v16, s[42:43]
    v_cndmask_b32 v27, 0, v16, s[44:45]
    s_mov_b32 s40, 0
    s_mov_b32 s41, -1
    v_bfe_u32 v16, v1, 1, 2
    v_mul_u32_u24 v16, 4160, v16
    v_lshrrev_b32 v17, 3, v1
    v_lshlrev_b32 v17, 10, v17
    v_and_b32 v18, 1, v1
    v_lshlrev_b32 v18, 9, v18
    v_add3_u32 v16, v16, v17, v18
    v_lshl_add_u32 v16, v2, 4, v16
    v_add_u32 v16, s51, v16
    v_mov_b32 v18, 146432
    v_mov_b64 v[176:177], 0
    v_mov_b64 v[178:179], 0
    v_mov_b64 v[180:181], 0
    v_mov_b64 v[182:183], 0
    v_mov_b64 v[184:185], 0
    v_mov_b64 v[186:187], 0
    v_mov_b64 v[188:189], 0
    v_mov_b64 v[190:191], 0
    s_branch PA1_s
PA1:
    s_setpc_b64 s[88:89]
PA1_s:
    s_barrier
    s_waitcnt vmcnt(6)
    buffer_load_dwordx4 v3, s[32:35], s57 offen offset:3072 nt lds
    s_add_u32 m0, s51, 8320
    s_waitcnt vmcnt(6)
    buffer_load_dwordx4 v3, s[32:35], s58 offen offset:0 nt lds
    s_waitcnt vmcnt(6)
    buffer_load_dwordx4 v3, s[32:35], s58 offen offset:1024 nt lds
    s_waitcnt vmcnt(6)
    buffer_load_dwordx4 v3, s[32:35], s58 offen offset:2048 nt lds
    s_waitcnt vmcnt(6)
    buffer_load_dwordx4 v3, s[32:35], s58 offen offset:3072 nt lds
    s_add_u32 m0, s51, 12480
    s_waitcnt vmcnt(6)
    buffer_load_dwordx4 v3, s[32:35], s59 offen offset:0 nt lds
    s_waitcnt vmcnt(6)
    buffer_load_dwordx4 v3, s[32:35], s59 offen offset:1024 nt lds
    s_waitcnt vmcnt(6)
    buffer_load_dwordx4 v3, s[32:35], s59 offen offset:2048 nt lds
    s_waitcnt vmcnt(6)
    buffer_load_dwordx4 v3, s[32:35], s59 offen offset:3072 nt lds
    s_waitcnt vmcnt(6)
    buffer_load_dwordx4 v[96:99], v4, s[36:39], s56 offen offset:0 nt
    s_waitcnt vmcnt(6)
    buffer_load_dwordx4 v[100:103], v4, s[36:39], s56 offen offset:2048 nt
    s_waitcnt vmcnt(6)
    buffer_load_dwordx4 v[104:107], v4, s[36:39], s56 offen offset:256 nt
    s_waitcnt vmcnt(6)
    buffer_load_dwordx4 v[108:111], v4, s[36:39], s56 offen offset:2304 nt
    s_waitcnt vmcnt(6)
    buffer_load_dwordx4 v[112:115], v4, s[36:39], s57 offen offset:0 nt
    s_waitcnt vmcnt(6)
    buffer_load_dwordx4 v[116:119], v4, s[36:39], s57 offen offset:2048 nt
    s_waitcnt vmcnt(6)
    buffer_load_dwordx4 v[120:123], v4, s[36:39], s57 offen offset:256 nt
    ds_read_b128 v[32:35], v16 offset:0
    ds_read_b128 v[36:39], v16 offset:64
    ds_read_b128 v[40:43], v16 offset:128
    ds_read_b128 v[44:47], v16 offset:192
    ds_read_b128 v[48:51], v16 offset:256
    ds_read_b128 v[52:55], v16 offset:320
    ds_read_b128 v[56:59], v16 offset:384
    ds_read_b128 v[60:63], v16 offset:448
    ds_read_b128 v[64:67], v16 offset:2048
    ds_read_b128 v[68:71], v16 offset:2112
    ds_read_b128 v[72:75], v16 offset:2176
    ds_read_b128 v[76:79], v16 offset:2240
    ds_read_b128 v[80:83], v16 offset:2304
    ds_read_b128 v[84:87], v16 offset:2368
    ds_read_b128 v[88:91], v16 offset:2432
    ds_read_b128 v[92:95], v16 offset:2496
    s_waitcnt vmcnt(6)
    buffer_load_dwordx4 v[124:127], v4, s[36:39], s57 offen offset:2304 nt
    s_waitcnt vmcnt(6)
    buffer_load_dwordx4 v[128:131], v4, s[36:39], s58 offen offset:0 nt
    s_waitcnt vmcnt(6)
    buffer_load_dwordx4 v[132:135], v4, s[36:39], s58 offen offset:2048 nt
    s_waitcnt vmcnt(6)
    buffer_load_dwordx4 v[136:139], v4, s[36:39], s58 offen offset:256 nt
    s_waitcnt vmcnt(6)
    buffer_load_dwordx4 v[140:143], v4, s[36:39], s58 offen offset:2304 nt
    s_waitcnt vmcnt(6)
    buffer_load_dwordx4 v[144:147], v4, s[36:39], s59 offen offset:0 nt
    s_waitcnt vmcnt(6)
    buffer_load_dwordx4 v[148:151], v4, s[36:39], s59 offen offset:2048 nt
    s_waitcnt vmcnt(6)
    buffer_load_dwordx4 v[152:155], v4, s[36:39], s59 offen offset:256 nt
    s_waitcnt vmcnt(6)
    buffer_load_dwordx4 v[156:159], v4, s[36:39], s59 offen offset:2304 nt
    s_mov_b32 s48, 1035512379
    s_mov_b32 s49, 1035512379
    s_barrier
    ds_read_b64 v[18:19], v18
    s_waitcnt lgkmcnt(0)
    v_readfirstlane_b32 s7, v18
    v_lshl_or_b32 v20, v19, 7, 1
    s_cmp_lg_u32 s7, 0
    s_cbranch_scc1 SL_A_qk
    s_branch L_A_qk
PA2:
    s_setpc_b64 s[88:89]
.p2align 6
L_A_bq:
    s_barrier
L_A_qk:
    ds_read_b128 v[160:163], v9 offset:0
    ds_read_b128 v[164:167], v9 offset:64
    ds_read_b128 v[168:171], v9 offset:128
    ds_read_b128 v[172:175], v9 offset:192
    s_waitcnt lgkmcnt(3)
    v_smfmac_f32_16x16x64_bf16 v[176:179], v[160:163], v[32:39], v5
    v_smfmac_f32_16x16x64_bf16 v[180:183], v[160:163], v[64:71], v5
    s_waitcnt lgkmcnt(2)
    v_smfmac_f32_16x16x64_bf16 v[176:179], v[164:167], v[40:47], v5
    v_smfmac_f32_16x16x64_bf16 v[180:183], v[164:167], v[72:79], v5
    s_waitcnt lgkmcnt(1)
    v_smfmac_f32_16x16x64_bf16 v[176:179], v[168:171], v[48:55], v5
    v_smfmac_f32_16x16x64_bf16 v[180:183], v[168:171], v[80:87], v5
    s_waitcnt lgkmcnt(0)
    v_smfmac_f32_16x16x64_bf16 v[176:179], v[172:175], v[56:63], v5
    v_smfmac_f32_16x16x64_bf16 v[180:183], v[172:175], v[88:95], v5
    s_nop 6
    v_pk_add_f32 v[192:193], v[176:177], v[178:179]
    v_pk_add_f32 v[194:195], v[180:181], v[182:183]
    v_max_f32 v196, v192, v194
    v_max_f32 v197, v193, v195
    v_cndmask_b32 v192, v192, v194, s[40:41]
    v_max_f32_dpp v196, v196, v196 row_ror:8 row_mask:0xf bank_mask:0xf
    v_max_f32_dpp v197, v197, v197 row_ror:8 row_mask:0xf bank_mask:0xf
    v_cndmask_b32 v193, v193, v195, s[40:41]
    v_max_f32_dpp v196, v196, v196 row_ror:4 row_mask:0xf bank_mask:0xf
    v_max_f32_dpp v197, v197, v197 row_ror:4 row_mask:0xf bank_mask:0xf
    v_mov_b32_dpp v192, v192 row_ror:8 row_mask:0xa bank_mask:0xf
    v_max_f32_dpp v196, v196, v196 row_ror:2 row_mask:0xf bank_mask:0xf
    v_max_f32_dpp v197, v197, v197 row_ror:2 row_mask:0xf bank_mask:0xf
    v_mov_b32_dpp v193, v193 row_ror:8 row_mask:0xa bank_mask:0xf
    v_max_f32_dpp v196, v196, v196 row_ror:1 row_mask:0xf bank_mask:0xf
    v_max_f32_dpp v197, v197, v197 row_ror:1 row_mask:0xf bank_mask:0xf
    v_pk_mul_f32 v[196:197], v[196:197], s[48:49]
    v_pk_fma_f32 v[192:193], v[192:193], s[48:49], v[196:197] neg_lo:[0,0,1] neg_hi:[0,0,1]
    v_exp_f32 v192, v192
    v_exp_f32 v193, v193
    v_cndmask_b32 v202, v196, v197, s[40:41]
    v_cvt_pk_bf16_f32 v200, v192, v193
    s_waitcnt vmcnt(8)
    v_permlane32_swap_b32 v192, v193
    v_and_b32_dpp v204, v200, v7 row_newbcast:0 row_mask:0xf bank_mask:0xf
    v_and_b32_dpp v205, v200, v8 row_newbcast:0 row_mask:0xf bank_mask:0xf
    v_and_b32_dpp v206, v200, v7 row_newbcast:1 row_mask:0xf bank_mask:0xf
    v_and_b32_dpp v207, v200, v8 row_newbcast:1 row_mask:0xf bank_mask:0xf
    v_add_f32 v203, v192, v193
    v_and_b32_dpp v208, v200, v7 row_newbcast:2 row_mask:0xf bank_mask:0xf
    v_smfmac_f32_16x16x64_bf16 v[184:187], v[204:207], v[96:103], v6
    v_add_f32_dpp v203, v203, v203 row_ror:8 row_mask:0xf bank_mask:0xf
    v_and_b32_dpp v209, v200, v8 row_newbcast:2 row_mask:0xf bank_mask:0xf
    v_smfmac_f32_16x16x64_bf16 v[188:191], v[204:207], v[104:111], v6
    v_add_f32_dpp v203, v203, v203 row_ror:4 row_mask:0xf bank_mask:0xf
    v_and_b32_dpp v210, v200, v7 row_newbcast:3 row_mask:0xf bank_mask:0xf
    v_and_b32_dpp v211, v200, v8 row_newbcast:3 row_mask:0xf bank_mask:0xf
    v_add_f32_dpp v203, v203, v203 row_ror:2 row_mask:0xf bank_mask:0xf
    v_and_b32_dpp v204, v200, v7 row_newbcast:4 row_mask:0xf bank_mask:0xf
    v_smfmac_f32_16x16x64_bf16 v[184:187], v[208:211], v[112:119], v6
    v_add_f32_dpp v203, v203, v203 row_ror:1 row_mask:0xf bank_mask:0xf
    v_and_b32_dpp v205, v200, v8 row_newbcast:4 row_mask:0xf bank_mask:0xf
    ds_write_b64 v13, v[202:203]
    v_smfmac_f32_16x16x64_bf16 v[188:191], v[208:211], v[120:127], v6
    v_and_b32_dpp v206, v200, v7 row_newbcast:5 row_mask:0xf bank_mask:0xf
    v_and_b32_dpp v207, v200, v8 row_newbcast:5 row_mask:0xf bank_mask:0xf
    v_and_b32_dpp v208, v200, v7 row_newbcast:6 row_mask:0xf bank_mask:0xf
    s_waitcnt vmcnt(4)
    v_smfmac_f32_16x16x64_bf16 v[184:187], v[204:207], v[128:135], v6
    v_and_b32_dpp v209, v200, v8 row_newbcast:6 row_mask:0xf bank_mask:0xf
    v_and_b32_dpp v210, v200, v7 row_newbcast:7 row_mask:0xf bank_mask:0xf
    v_smfmac_f32_16x16x64_bf16 v[188:191], v[204:207], v[136:143], v6
    v_and_b32_dpp v211, v200, v8 row_newbcast:7 row_mask:0xf bank_mask:0xf
    ds_read_b64 v[220:221], v14
    ds_read_b32 v222, v10
    s_waitcnt vmcnt(0)
    v_smfmac_f32_16x16x64_bf16 v[184:187], v[208:211], v[144:151], v6
    v_smfmac_f32_16x16x64_bf16 v[188:191], v[208:211], v[152:159], v6
L_A_m:
    s_waitcnt lgkmcnt(0)
    v_max_f32_dpp v197, v220, v220 quad_perm:[1,0,3,2] row_mask:0xf bank_mask:0xf
    s_nop 1
    v_max_f32_dpp v197, v197, v197 quad_perm:[2,3,0,1] row_mask:0xf bank_mask:0xf
    v_sub_f32 v192, v220, v197
    v_exp_f32 v192, v192
    v_cvt_pk_bf16_f32 v212, v184, v185
    v_cvt_pk_bf16_f32 v213, v186, v187
    v_mul_f32 v192, v192, v221
    v_cvt_pk_bf16_f32 v214, v188, v189
    v_cvt_pk_bf16_f32 v215, v190, v191
    ds_write_b128 v11, v[212:215]
    v_add_f32_dpp v192, v192, v192 quad_perm:[1,0,3,2] row_mask:0xf bank_mask:0xf
    v_sub_f32 v224, v222, v197
    v_exp_f32 v224, v224
    v_add_f32_dpp v192, v192, v192 quad_perm:[2,3,0,1] row_mask:0xf bank_mask:0xf
    v_cmp_u_f32 vcc, v192, v192
    v_rcp_f32 v193, v192
    v_log_f32 v192, v192
    v_mul_f32 v224, v224, v193
    v_add_f32 v192, v192, v197
    v_cvt_pk_bf16_f32 v224, v224, v224
    s_cbranch_vccnz L_A_mr
L_A_mok:
    v_xor_b32 v217, v192, v19
    v_xor_b32 v219, v192, v20
    v_and_b32 v204, v224, v24
    v_and_b32 v205, v224, v25
    v_and_b32 v206, v224, v26
    v_and_b32 v207, v224, v27
    s_waitcnt lgkmcnt(0)
    s_barrier
L_A_x:
    ds_read_b128 v[226:229], v12
    s_waitcnt lgkmcnt(0)
    v_mfma_f32_16x16x32_bf16 v[176:179], v[204:207], v[226:229], 0
    s_nop 7
    v_cvt_pk_bf16_f32 v216, v176, v177
    v_cvt_pk_bf16_f32 v218, v178, v179
    buffer_store_dwordx4 v[216:219], v15, s[28:31], s6 offen
    s_barrier
    s_cmp_lg_u32 s26, 0
    s_cbranch_scc1 L_A_end
    v_mov_b64 v[184:185], 0
    v_mov_b64 v[186:187], 0
    v_mov_b64 v[188:189], 0
    v_mov_b64 v[190:191], 0
    v_mov_b64 v[176:177], 0
    v_mov_b64 v[178:179], 0
    v_mov_b64 v[180:181], 0
    v_mov_b64 v[182:183], 0
    v_add_u32 v13, 64, v13
    v_add_u32 v14, 64, v14
    v_add_u32 v10, 64, v10
    s_add_u32 s6, s6, 73728
    s_mov_b32 s26, 1
    s_barrier
    s_barrier
    s_cmp_lt_u32 s5, 26
    s_cbranch_scc0 L_A_bq
    s_sub_u32 s54, s5, 15
    s_cmp_lt_u32 s54, 4
    s_cbranch_scc1 L_A_bq
    s_barrier
    s_branch L_A_bq
L_A_mr:
    v_cmp_eq_u32 vcc, s52, v221
    s_cbranch_vccz L_A_mok
    ds_read_b64 v[220:221], v14
    ds_read_b32 v222, v10
    s_add_u32 s53, s53, 1
    s_cmp_gt_u32 s53, 1048576
    s_cbranch_scc1 L_exit
    s_branch L_A_m
L_A_end:
    s_endpgm
.p2align 12
PB0:
    s_setpc_b64 s[88:89]
L_G:
    s_cmp_lg_u32 s3, 1
    s_cbranch_scc1 Lc_5
    s_call_b64 s[88:89], PB1
Lc_5:
    s_cmp_lg_u32 s3, 2
    s_cbranch_scc1 Lc_6
    s_call_b64 s[88:89], PA1
Lc_6:
    s_cmp_lg_u32 s3, 3
    s_cbranch_scc1 Lc_7
    s_call_b64 s[88:89], PC1
Lc_7:
    s_cmp_eq_u32 s3, 0
    s_cbranch_scc1 L_G_h1
    s_barrier
L_G_h1:
    s_cmp_lg_u32 s3, 1
    s_cbranch_scc1 Lc_9
    s_call_b64 s[88:89], PA2
    s_call_b64 s[88:89], PC2
Lc_9:
    s_cmp_lg_u32 s3, 2
    s_cbranch_scc1 Lc_10
    s_call_b64 s[88:89], PC0
    s_call_b64 s[88:89], PC3
Lc_10:
    s_cmp_lg_u32 s3, 3
    s_cbranch_scc1 Lc_11
    s_call_b64 s[88:89], PB2
Lc_11:
L_G1_back:
    s_mov_b64 exec, -1
    s_mov_b32 s30, 3145728
    s_mov_b32 s31, 0x20000
    s_mul_i32 s6, s4, 147456
    s_add_u32 s6, s6, 262144
    s_mov_b32 s52, 4289068965
    s_mov_b32 s53, 0
    s_mov_b32 s26, 0
    s_mov_b32 s27, 0
    v_and_b32 v1, 15, v0
    v_lshrrev_b32 v2, 4, v0
    s_waitcnt lgkmcnt(0)
    s_load_dword s42, s[28:29], 0
    s_mov_b64 s[36:37], s[8:9]
    s_movk_i32 s38, 896
    s_mov_b32 s39, s35
    s_mul_i32 s59, s3, 1088
    s_add_u32 s59, s59, 66560
    v_mov_b32 v19, 1073741824
    v_mov_b32 v28, s52
    v_mov_b32 v15, v19
    v_mov_b32 v6, v19
    v_mov_b32 v9, 0
    v_mov_b32 v10, v19
    v_mov_b32 v11, v19
    v_mov_b32 v13, v19
    v_mov_b32 v14, v19
    v_mov_b32 v24, v19
    v_mov_b32 v26, v19
    v_mov_b32 v125, 0
    v_and_b32 v21, 1, v0
    v_mul_u32_u24 v4, 0xaaaa, v21
    v_add_u32 v4, 0x4444, v4
    v_mov_b32 v5, 0x3f803f80
    v_lshrrev_b32 v20, 3, v1
    v_mul_u32_u24 v20, 1088, v20
    v_and_b32 v22, 1, v2
    v_lshl_add_u32 v20, v22, 9, v20
    v_xor_b32 v22, s3, v22
    v_lshl_add_u32 v20, v22, 5, v20
    v_bfe_u32 v22, v1, 2, 1
    v_lshl_add_u32 v20, v22, 7, v20
    v_and_b32 v22, 3, v1
    v_lshl_add_u32 v20, v22, 3, v20
    v_add_u32 v7, 66560, v20
    v_lshrrev_b32 v22, 1, v2
    v_mul_u32_u24 v22, 4352, v22
    v_add_u32 v30, v22, v7
    v_xor_b32 v31, 32, v30
    v_bfe_u32 v23, v1, 1, 1
    v_lshlrev_b32 v23, 5, v23
    v_lshrrev_b32 v22, 2, v1
    v_lshl_add_u32 v23, v22, 2, v23
    v_lshl_add_u32 v23, v21, 1, v23
    s_xor_b32 s55, s5, 16
    s_and_b32 s54, s55, 12
    s_lshl_b32 s54, s54, 4
    s_and_b32 s55, s55, 16
    s_add_u32 s54, s54, s55
    v_lshl_add_u32 v20, v2, 8, v23
    v_add_u32 v20, s54, v20
    s_lshl_b32 s54, s4, 13
    s_and_b32 s55, s5, 3
    s_lshl_b32 s55, s55, 11
    s_add_u32 s54, s54, s55
    s_add_u32 s54, s54, 1703936
    v_cmp_eq_u32 vcc, 0, v21
    v_and_b32 v22, 8, v20
    v_lshlrev_b32 v22, 7, v22
    v_and_b32 v21, 4, v20
    v_lshl_add_u32 v22, v21, 1, v22
    v_and_b32 v20, 0x3f0, v20
    v_add3_u32 v20, v20, v22, s54
    s_getreg_b32 s43, hwreg(HW_REG_XCC_ID)
    s_and_b32 s43, s43, 15
    v_cndmask_b32 v29, v19, v20, vcc
    s_mov_b32 s40, 0
    s_mov_b32 s27, 3
    s_movk_i32 s45, 0xfff
    s_mov_b32 s7, 2
    s_cmp_lg_u32 s3, 0
    s_cbranch_scc1 L_G_set
    v_mov_b64 v[160:161], 0
    v_mov_b64 v[162:163], 0
    v_mov_b64 v[164:165], 0
    v_mov_b64 v[166:167], 0
    v_mov_b64 v[168:169], 0
    v_mov_b64 v[170:171], 0
    v_mov_b64 v[172:173], 0
    v_mov_b64 v[174:175], 0
    v_mov_b64 v[176:177], 0
    v_mov_b64 v[178:179], 0
    v_mov_b64 v[180:181], 0
    v_mov_b64 v[182:183], 0
    v_mov_b64 v[184:185], 0
    v_mov_b64 v[186:187], 0
    v_mov_b64 v[188:189], 0
    v_mov_b64 v[190:191], 0
    v_and_b32 v20, 2, v0
    v_cmp_ne_u32 s[92:93], 0, v20
    s_mov_b32 s94, 0x000f000f
    s_mov_b32 s95, s94
    v_mov_b64 v[108:109], 0
    v_mov_b64 v[110:111], 0
    s_waitcnt lgkmcnt(0)
    s_waitcnt vmcnt(0)
    s_add_u32 s96, s42, 0x9e3779b0
    s_and_b32 s96, s96, 0xfffffff0
L_Q1_x:
    ds_read_b64_tr_b16 v[32:33], v30 offset:0
    ds_read_b64_tr_b16 v[34:35], v30 offset:256
    ds_read_b64_tr_b16 v[36:37], v30 offset:8704
    ds_read_b64_tr_b16 v[38:39], v30 offset:8960
    ds_read_b64_tr_b16 v[40:41], v30 offset:2176
    ds_read_b64_tr_b16 v[42:43], v30 offset:2432
    ds_read_b64_tr_b16 v[44:45], v30 offset:10880
    ds_read_b64_tr_b16 v[46:47], v30 offset:11136
    ds_read_b64_tr_b16 v[48:49], v31 offset:0
    ds_read_b64_tr_b16 v[50:51], v31 offset:256
    ds_read_b64_tr_b16 v[52:53], v31 offset:8704
    ds_read_b64_tr_b16 v[54:55], v31 offset:8960
    ds_read_b64_tr_b16 v[56:57], v31 offset:2176
    ds_read_b64_tr_b16 v[58:59], v31 offset:2432
    ds_read_b64_tr_b16 v[60:61], v31 offset:10880
    ds_read_b64_tr_b16 v[62:63], v31 offset:11136
    ds_read_b64_tr_b16 v[64:65], v30 offset:64
    ds_read_b64_tr_b16 v[66:67], v30 offset:320
    ds_read_b64_tr_b16 v[68:69], v30 offset:8768
    ds_read_b64_tr_b16 v[70:71], v30 offset:9024
    ds_read_b64_tr_b16 v[72:73], v30 offset:2240
    ds_read_b64_tr_b16 v[74:75], v30 offset:2496
    ds_read_b64_tr_b16 v[76:77], v30 offset:10944
    ds_read_b64_tr_b16 v[78:79], v30 offset:11200
    ds_read_b64_tr_b16 v[80:81], v31 offset:64
    ds_read_b64_tr_b16 v[82:83], v31 offset:320
    ds_read_b64_tr_b16 v[84:85], v31 offset:8768
    ds_read_b64_tr_b16 v[86:87], v31 offset:9024
    ds_read_b64_tr_b16 v[88:89], v31 offset:2240
    ds_read_b64_tr_b16 v[90:91], v31 offset:2496
    ds_read_b64_tr_b16 v[92:93], v31 offset:10944
    ds_read_b64_tr_b16 v[94:95], v31 offset:11200
    v_cndmask_b32 v128, v128, v5, s[92:93]
    v_cndmask_b32 v129, v129, v5, s[92:93]
    v_cndmask_b32 v130, v130, v5, s[92:93]
    v_cndmask_b32 v131, v131, v5, s[92:93]
    v_cndmask_b32 v132, v132, v5, s[92:93]
    v_cndmask_b32 v133, v133, v5, s[92:93]
    v_cndmask_b32 v134, v134, v5, s[92:93]
    v_cndmask_b32 v135, v135, v5, s[92:93]
    s_branch PB1_s
PB1:
    s_setpc_b64 s[88:89]
PB1_s:
    s_mov_b64 s[54:55], exec
    s_lshl_b64 exec, s[94:95], 0
    v_mov_b64 v[160:161], v[128:129]
    v_mov_b64 v[162:163], v[130:131]
    v_mov_b64 v[164:165], v[132:133]
    v_mov_b64 v[166:167], v[134:135]
    s_lshl_b64 exec, s[94:95], 4
    v_mov_b64 v[168:169], v[128:129]
    v_mov_b64 v[170:171], v[130:131]
    v_mov_b64 v[172:173], v[132:133]
    v_mov_b64 v[174:175], v[134:135]
    s_lshl_b64 exec, s[94:95], 8
    v_mov_b64 v[176:177], v[128:129]
    v_mov_b64 v[178:179], v[130:131]
    v_mov_b64 v[180:181], v[132:133]
    v_mov_b64 v[182:183], v[134:135]
    s_lshl_b64 exec, s[94:95], 12
    v_mov_b64 v[184:185], v[128:129]
    v_mov_b64 v[186:187], v[130:131]
    v_mov_b64 v[188:189], v[132:133]
    v_mov_b64 v[190:191], v[134:135]
    s_mov_b64 exec, s[54:55]
    v_dot2_f32_bf16 v113, v96, v96, 0
    v_dot2_f32_bf16 v113, v97, v97, v113
    v_dot2_f32_bf16 v113, v98, v98, v113
    v_dot2_f32_bf16 v113, v99, v99, v113
    v_dot2_f32_bf16 v112, v96, v5, 0
    v_dot2_f32_bf16 v112, v97, v5, v112
    v_dot2_f32_bf16 v112, v98, v5, v112
    v_dot2_f32_bf16 v112, v99, v5, v112
    s_waitcnt lgkmcnt(0)
    v_smfmac_f32_16x16x64_bf16 v[108:111], v[160:163], v[32:39], v4
    s_nop 0
    v_permlane32_swap_b32 v112, v113
    v_add_f32 v112, v112, v113
    v_smfmac_f32_16x16x64_bf16 v[108:111], v[164:167], v[40:47], v4
    s_nop 0
    v_add_f32_dpp v112, v112, v112 row_ror:8 row_mask:0xf bank_mask:0xf
    v_smfmac_f32_16x16x64_bf16 v[108:111], v[168:171], v[48:55], v4
    s_nop 0
    v_add_f32_dpp v112, v112, v112 row_ror:4 row_mask:0xf bank_mask:0xf
    v_smfmac_f32_16x16x64_bf16 v[108:111], v[172:175], v[56:63], v4
    s_nop 0
    v_add_f32_dpp v112, v112, v112 row_ror:2 row_mask:0xf bank_mask:0xf
    v_smfmac_f32_16x16x64_bf16 v[108:111], v[176:179], v[64:71], v4
    s_nop 0
    v_add_f32_dpp v112, v112, v112 row_ror:1 row_mask:0xf bank_mask:0xf
    v_smfmac_f32_16x16x64_bf16 v[108:111], v[180:183], v[72:79], v4
    s_nop 0
    v_add_f32_dpp v112, v112, v112 row_bcast:15 row_mask:0xa bank_mask:0xf
    v_mul_f32 v112, 0x3b124925, v112
    v_smfmac_f32_16x16x64_bf16 v[108:111], v[184:187], v[80:87], v4
    v_readlane_b32 s98, v112, 16
    v_readlane_b32 s99, v112, 48
    v_smfmac_f32_16x16x64_bf16 v[108:111], v[188:191], v[88:95], v4
    v_mov_b32 v117, s98
    v_fma_f32 v118, -v117, v117, s99
    v_max_f32 v119, 0, v118
    v_add_f32 v119, 0x3727c5ac, v119
    v_rsq_f32 v119, v119
    s_mov_b32 s54, 65536
    s_or_b32 s55, s96, s43
    s_nop 0
    v_add_f32 v116, v108, v109
    v_add_f32 v118, v110, v111
    v_fma_f32 v116, -v117, v118, v116
    v_mul_f32 v116, v116, v119
    s_nop 1
    v_mov_b32_dpp v117, v116 row_shl:1 row_mask:0xf bank_mask:0xf
    v_cvt_pk_bf16_f32 v116, v116, v117
    v_mov_b32 v117, s55
    buffer_store_dwordx2 v[116:117], v29, s[28:31], 0 offen
    buffer_store_dwordx2 v[116:117], v29, s[28:31], s54 offen sc1
    s_barrier
L_G_set:
    s_mov_b32 s96, 0x3727c5ac
    v_mov_b32 v140, 0x3b124925
    v_cmp_lt_u32 vcc, 31, v0
    v_mov_b32 v141, s96
    s_nop 0
    v_cndmask_b32 v141, 0, v141, vcc
    s_mov_b32 s44, 131072
    s_add_u32 s56, s6, 69632
    s_add_u32 s57, s6, 70656
    s_movk_i32 s58, 112
    s_movk_i32 s50, 64
    s_cmp_ge_u32 s5, 26
    s_cbranch_scc1 L_G_rn
    s_cmp_ge_u32 s5, 19
    s_cbranch_scc1 L_G_rf2
    s_cmp_ge_u32 s5, 15
    s_cbranch_scc1 L_G_rf1
    s_cmp_ge_u32 s5, 8
    s_cbranch_scc1 L_G_ro
    s_mov_b32 s41, s5
    s_lshl_b32 s54, s4, 10
    s_movk_i32 s48, 8192
    s_movk_i32 s49, 448
    s_mov_b32 s34, 3670016
    s_mov_b64 s[32:33], s[14:15]
    s_mov_b32 s46, s57
    s_lshl_b32 s55, s5, 1
    s_add_u32 s55, s55, s3
    s_cmp_lt_u32 s3, 2
    s_cselect_b32 s50, s55, 64
    s_branch L_G_w
L_G_rn:
    s_mov_b32 s40, 4
    s_mov_b32 s41, 0
    s_mul_i32 s55, s5, 3
    s_add_u32 s55, s55, s3
    s_sub_u32 s55, s55, 62
    s_cmp_lt_u32 s3, 3
    s_cselect_b32 s50, s55, 64
    s_mov_b32 s54, 0
    s_mov_b32 s34, 0
    s_mov_b64 s[32:33], s[14:15]
    s_mov_b32 s48, 0
    s_mov_b32 s49, 0
    s_mov_b32 s46, s57
    s_branch L_G_w
L_G_ro:
    s_mov_b32 s40, 1
    s_sub_u32 s41, s5, 8
    s_movk_i32 s58, 128
    s_mul_i32 s54, s4, 458752
    s_movk_i32 s48, 896
    s_movk_i32 s49, 512
    s_mov_b32 s34, 3670016
    s_mov_b64 s[32:33], s[16:17]
    s_add_u32 s46, s6, 67584
    s_branch L_G_w
L_G_rf1:
    s_mov_b32 s40, 2
    s_sub_u32 s41, s5, 15
    s_mul_i32 s54, s4, 448
    s_andn2_b32 s54, s54, 127
    s_movk_i32 s48, 3584
    s_movk_i32 s49, 448
    s_mov_b32 s34, 1605632
    s_mov_b64 s[32:33], s[20:21]
    s_mov_b32 s46, s56
    s_branch L_G_w
L_G_rf2:
    s_mov_b32 s40, 3
    s_sub_u32 s41, s5, 19
    s_movk_i32 s58, 64
    s_mul_i32 s54, s4, 200704
    s_movk_i32 s48, 896
    s_movk_i32 s49, 256
    s_mov_b32 s34, 1605632
    s_mov_b64 s[32:33], s[22:23]
    s_mov_b32 s44, 163840
    s_add_u32 s46, s6, 68608
    s_mov_b32 s56, s57
L_G_w:
    s_lshl_b32 s55, s41, 7
    s_add_u32 s54, s54, s55
    s_sub_u32 s34, s34, s54
    s_add_u32 s32, s32, s54
    s_addc_u32 s33, s33, 0
    v_mul_lo_u32 v16, v18, s48
    v_add_u32 v16, v16, v17
    s_mul_i32 s49, s49, s48
    s_lshl_b32 s55, s48, 3
    s_mul_i32 s47, s3, s55
    s_lshl_b32 s48, s48, 5
    s_lshl_b32 s41, s41, 2
    s_add_u32 s41, s41, s3
    s_and_b32 s54, s4, 1
    s_lshl_b32 s54, s54, 1
    s_cmp_eq_u32 s40, 2
    s_cselect_b32 s54, s54, 0
    s_sub_u32 s41, s41, s54
    s_lshr_b32 s54, s58, 3
    v_mul_u32_u24 v20, s54, v2
    v_add_u32 v20, v20, v1
    v_cmp_gt_u32 vcc, s54, v1
    s_mul_i32 s51, s54, 1088
    s_cmp_eq_u32 s40, 3
    s_cselect_b32 s55, 28, 64
    v_cmp_gt_u32 s[54:55], s55, v20
    s_and_b64 vcc, vcc, s[54:55]
    v_lshlrev_b32 v20, 4, v20
    v_lshrrev_b32 v21, 1, v2
    v_cndmask_b32 v3, v19, v20, vcc
    v_mad_u32_u24 v7, v21, s51, v7
    s_lshl_b32 s51, s51, 1
    v_add_u32 v8, s51, v7
    v_and_b32 v22, 7, v0
    v_lshlrev_b32 v20, 2, v22
    v_lshrrev_b32 v21, 5, v0
    v_lshl_add_u32 v20, v21, 1, v20
    s_min_u32 s55, s41, 27
    s_lshl_b32 s55, s55, 5
    v_add_u32 v11, s55, v20
    v_and_b32 v20, 16, v0
    v_cmp_eq_u32 vcc, 0, v20
    v_and_b32 v20, 8, v0
    s_nop 0
    v_cndmask_b32 v11, v19, v11, vcc
    v_cmp_eq_u32 vcc, 0, v20
    s_lshl_b32 s54, s41, 10
    v_lshlrev_b32 v20, 7, v18
    v_lshl_add_u32 v20, v22, 3, v20
    v_cndmask_b32 v10, v19, v11, vcc
    v_add_u32 v9, s54, v20
    s_branch PB2_s
PB2:
    s_setpc_b64 s[88:89]
PB2_s:
    s_waitcnt lgkmcnt(0)
    s_add_u32 s42, s42, 0x9e3779b0
    s_and_b32 s42, s42, 0xfffffff0
    s_lshl_b32 s97, s42, 7
    s_xor_b32 s97, s97, s42
    s_or_b32 s97, s97, 1
    s_lshl_b32 s55, s50, 11
    v_lshl_add_u32 v13, v0, 4, s55
    s_lshl_b32 s55, s50, 5
    s_add_u32 s55, s55, 67584
    v_and_b32 v20, 1, v2
    v_lshlrev_b32 v20, 1, v20
    v_lshrrev_b32 v21, 1, v2
    v_add_u32 v20, v20, v21
    v_cmp_gt_u32 vcc, 4, v1
    v_lshl_add_u32 v20, v1, 2, v20
    v_lshl_add_u32 v20, v20, 1, s55
    v_cndmask_b32 v14, v19, v20, vcc
    v_lshlrev_b32 v24, 7, v0
    v_add_u32 v24, 65536, v24
    v_cmp_gt_u32 vcc, 16, v0
    s_lshl_b32 s55, s4, 7
    s_add_u32 s54, s54, s55
    v_lshl_add_u32 v20, v0, 2, s54
    s_and_b32 s55, s40, 1
    s_cbranch_scc1 L_G_i2
    s_lshl_b32 s54, s41, 5
    s_add_u32 s54, s54, 68608
    v_lshl_add_u32 v20, v0, 1, s54
    s_cmp_eq_u32 s40, 2
    s_cbranch_scc1 L_G_i2
    s_lshl_b32 s54, s3, 8
    s_and_b32 s55, s41, 12
    s_lshl_b32 s55, s55, 4
    s_add_u32 s54, s54, s55
    s_and_b32 s55, s41, 16
    s_add_u32 s54, s54, s55
    s_add_u32 s54, s54, 145408
    v_add_u32 v20, s54, v23
L_G_i2:
    v_cndmask_b32 v6, v19, v20, vcc
L_G_io:
    s_and_b32 s55, s40, 1
    s_cbranch_scc0 L_G_dry0
    s_lshr_b32 s54, s40, 1
    s_lshl_b32 s54, s54, 5
    s_add_u32 s54, s54, s41
    s_lshl_b32 s54, s54, 7
    s_add_u32 s54, s54, 4096
    v_lshl_add_u32 v15, v0, 2, s54
    s_cmp_eq_u32 s3, 0
    s_cbranch_scc1 L_G_dry0
    s_add_u32 s55, s44, 0x10000
    buffer_store_dword v28, v6, s[28:31], s44 offen sc1
    buffer_store_dword v28, v6, s[28:31], s55 offen sc1
    buffer_store_dword v28, v6, s[28:31], s55 offen offset:64 sc1
    v_cmp_eq_u32 vcc, s4, v0
    v_mov_b32 v21, s42
    v_subrev_u32 v25, 128, v15
    s_cmp_eq_u32 s3, 1
    v_cndmask_b32 v25, v19, v25, vcc
    s_cbranch_scc0 L_G_io2
    s_sub_u32 s54, s44, 1024
    s_sub_u32 s55, s55, 1024
    buffer_store_dword v28, v6, s[28:31], s54 offen sc1
    buffer_store_dword v28, v6, s[28:31], s55 offen sc1
    buffer_store_dword v28, v6, s[28:31], s55 offen offset:64 sc1
    s_waitcnt vmcnt(0)
    buffer_store_dword v21, v25, s[28:31], 0 offen sc1
    s_branch L_G_io3
L_G_io2:
    s_waitcnt vmcnt(0)
L_G_io3:
    buffer_store_dword v21, v25, s[28:31], 0 offen offset:128 sc1
L_G_dry0:
L_G_dry1:
L_G_dry2:
    s_mov_b64 exec, -1
    s_nop 4
    v_mov_b64 v[108:109], 0
    v_mov_b64 v[110:111], 0
    s_cmp_eq_u32 s3, 0
    s_cbranch_scc0 L_G_bq
    s_waitcnt vmcnt(0)
    s_lshl_b32 s54, s4, 13
    s_add_u32 s54, s54, 1703936
    v_lshl_add_u32 v28, v0, 4, s54
    v_add_u32 v29, 4096, v28
    s_mov_b32 s51, 0
    s_sleep 6
    s_mov_b32 s92, 1
L_G_q1a:
    buffer_load_dwordx4 v[160:163], v28, s[28:31], s51 offen offset:0 sc1
    buffer_load_dwordx4 v[164:167], v28, s[28:31], s51 offen offset:1024 sc1
    buffer_load_dwordx4 v[168:171], v28, s[28:31], s51 offen offset:2048 sc1
    buffer_load_dwordx4 v[172:175], v28, s[28:31], s51 offen offset:3072 sc1
    buffer_load_dwordx4 v[176:179], v29, s[28:31], s51 offen offset:0 sc1
    buffer_load_dwordx4 v[180:183], v29, s[28:31], s51 offen offset:1024 sc1
    buffer_load_dwordx4 v[184:187], v29, s[28:31], s51 offen offset:2048 sc1
    buffer_load_dwordx4 v[188:191], v29, s[28:31], s51 offen offset:3072 sc1
    s_sub_u32 s92, s92, 1
    s_cmp_eq_u32 s92, 0
    s_cbranch_scc1 L_G_q1b
    s_sleep 18
    s_branch L_G_q1a
L_G_q1b:
    s_mov_b32 s92, 1
L_G_q1poll:
    s_add_u32 s53, s53, 1
    s_cmp_gt_u32 s53, 1048576
    s_cbranch_scc1 L_exit
    s_cmp_eq_u32 s92, 1
    s_cbranch_scc1 L_G_q1w
    s_and_b32 s54, s53, 1
    s_cselect_b32 s51, 65536, 0
    s_mov_b32 s92, 1
    buffer_load_dwordx4 v[160:163], v28, s[28:31], s51 offen offset:0 sc1
    buffer_load_dwordx4 v[164:167], v28, s[28:31], s51 offen offset:1024 sc1
    buffer_load_dwordx4 v[168:171], v28, s[28:31], s51 offen offset:2048 sc1
    buffer_load_dwordx4 v[172:175], v28, s[28:31], s51 offen offset:3072 sc1
    buffer_load_dwordx4 v[176:179], v29, s[28:31], s51 offen offset:0 sc1
    buffer_load_dwordx4 v[180:183], v29, s[28:31], s51 offen offset:1024 sc1
    buffer_load_dwordx4 v[184:187], v29, s[28:31], s51 offen offset:2048 sc1
    buffer_load_dwordx4 v[188:191], v29, s[28:31], s51 offen offset:3072 sc1
L_G_q1w:
    s_waitcnt vmcnt(0)
L_G_q1c:
    s_sub_u32 s92, s92, 1
    s_or_b32 s54, s42, s43
    v_mov_b32 v20, 0
    v_bitop3_b32 v21, v161, v163, s54 bitop3:0x7e
    v_or_b32 v20, v20, v21
    v_bitop3_b32 v21, v165, v167, s54 bitop3:0x7e
    v_or_b32 v20, v20, v21
    v_bitop3_b32 v21, v169, v171, s54 bitop3:0x7e
    v_or_b32 v20, v20, v21
    v_bitop3_b32 v21, v173, v175, s54 bitop3:0x7e
    v_or_b32 v20, v20, v21
    v_bitop3_b32 v21, v177, v179, s54 bitop3:0x7e
    v_or_b32 v20, v20, v21
    v_bitop3_b32 v21, v181, v183, s54 bitop3:0x7e
    v_or_b32 v20, v20, v21
    v_bitop3_b32 v21, v185, v187, s54 bitop3:0x7e
    v_or_b32 v20, v20, v21
    v_bitop3_b32 v21, v189, v191, s54 bitop3:0x7e
    v_or_b32 v20, v20, v21
    v_cmp_lt_u32 vcc, 15, v20
    s_cbranch_vccnz L_G_q1poll
    v_cmp_ne_u32 vcc, 0, v20
    s_cmp_lg_u64 vcc, 0
    s_cselect_b32 s7, 1, 0
    v_and_b32 v193, 0xffff0000, v160
    v_lshlrev_b32 v192, 16, v160
    v_and_b32 v195, 0xffff0000, v168
    v_lshlrev_b32 v194, 16, v168
    v_and_b32 v197, 0xffff0000, v176
    v_lshlrev_b32 v196, 16, v176
    v_and_b32 v199, 0xffff0000, v184
    v_lshlrev_b32 v198, 16, v184
    v_pk_add_f32 v[192:193], v[192:193], v[194:195]
    v_pk_add_f32 v[192:193], v[192:193], v[196:197]
    v_pk_add_f32 v[192:193], v[192:193], v[198:199]
    v_cvt_pk_bf16_f32 v20, v192, v193
    v_and_b32 v193, 0xffff0000, v162
    v_lshlrev_b32 v192, 16, v162
    v_and_b32 v195, 0xffff0000, v170
    v_lshlrev_b32 v194, 16, v170
    v_and_b32 v197, 0xffff0000, v178
    v_lshlrev_b32 v196, 16, v178
    v_and_b32 v199, 0xffff0000, v186
    v_lshlrev_b32 v198, 16, v186
    v_pk_add_f32 v[192:193], v[192:193], v[194:195]
    v_pk_add_f32 v[192:193], v[192:193], v[196:197]
    v_pk_add_f32 v[192:193], v[192:193], v[198:199]
    v_cvt_pk_bf16_f32 v21, v192, v193
    v_and_b32 v193, 0xffff0000, v164
    v_lshlrev_b32 v192, 16, v164
    v_and_b32 v195, 0xffff0000, v172
    v_lshlrev_b32 v194, 16, v172
    v_and_b32 v197, 0xffff0000, v180
    v_lshlrev_b32 v196, 16, v180
    v_and_b32 v199, 0xffff0000, v188
    v_lshlrev_b32 v198, 16, v188
    v_pk_add_f32 v[192:193], v[192:193], v[194:195]
    v_pk_add_f32 v[192:193], v[192:193], v[196:197]
    v_pk_add_f32 v[192:193], v[192:193], v[198:199]
    v_cvt_pk_bf16_f32 v22, v192, v193
    v_and_b32 v193, 0xffff0000, v166
    v_lshlrev_b32 v192, 16, v166
    v_and_b32 v195, 0xffff0000, v174
    v_lshlrev_b32 v194, 16, v174
    v_and_b32 v197, 0xffff0000, v182
    v_lshlrev_b32 v196, 16, v182
    v_and_b32 v199, 0xffff0000, v190
    v_lshlrev_b32 v198, 16, v190
    v_pk_add_f32 v[192:193], v[192:193], v[194:195]
    v_pk_add_f32 v[192:193], v[192:193], v[196:197]
    v_pk_add_f32 v[192:193], v[192:193], v[198:199]
    v_cvt_pk_bf16_f32 v23, v192, v193
    v_lshlrev_b32 v25, 4, v0
    v_add_u32 v25, 144384, v25
    ds_write_b128 v25, v[20:23]
    v_mov_b32 v25, 146432
    v_mov_b32 v26, s7
    v_mov_b32 v27, s42
    ds_write_b64 v25, v[26:27]
    v_lshlrev_b32 v25, 2, v0
    v_add_u32 v25, 145408, v25
    v_mov_b32 v26, s52
    ds_write_b32 v25, v26
    s_waitcnt lgkmcnt(0)
    s_branch PB3_s
PB3:
    s_setpc_b64 s[88:89]
PB3_s:
L_G_bq:
    s_cmp_lt_u32 s5, 8
    s_cselect_b32 s55, 7, 0
    s_add_u32 s55, s55, s5
    s_lshl_b32 s54, s4, 5
    s_add_u32 s54, s54, s55
    s_lshl_b32 s54, s54, 2
    s_add_u32 s54, s54, s3
    s_mul_i32 s54, s54, 3584
    v_lshl_add_u32 v22, v0, 7, s54
    s_min_u32 s54, s41, 27
    s_lshl_b32 s54, s54, 3
    s_add_u32 s54, s54, 224
    v_bfe_u32 v23, v0, 2, 3
    v_add_u32 v23, s54, v23
    v_mul_u32_u24 v23, 3584, v23
    s_mul_i32 s54, s4, 448
    s_andn2_b32 s54, s54, 127
    v_and_b32 v20, 3, v0
    v_lshl_add_u32 v23, v20, 7, v23
    v_add_u32 v23, s54, v23
    v_mov_b32 v20, 146432
    s_mov_b32 m0, s59
    s_barrier
    ds_read_b32 v20, v20
    s_cmp_lt_u32 s50, 32
    s_cbranch_scc0 L_G_p1
    buffer_load_dwordx4 v[132:135], v13, s[28:31], s6 offen sc1
    buffer_load_dwordx4 v[136:139], v13, s[28:31], s6 offen offset:1024 sc1
    s_branch L_G_p2
L_G_p1:
    s_and_b32 s54, s40, 1
    s_cbranch_scc0 L_G_p3
    buffer_load_ushort v124, v11, s[36:39], 0 offen
    s_mov_b32 s36, s28
    s_mov_b32 s37, s29
    s_mov_b32 s38, 3145728
L_G_p3:
    s_cmp_eq_u32 s40, 4
    s_cbranch_scc0 L_G_p2
    buffer_load_dword v230, v24, s[28:31], s6 offen sc1
L_G_p2:
    s_waitcnt lgkmcnt(0)
    v_readfirstlane_b32 s7, v20
    s_cmp_eq_u32 s40, 1
    s_cbranch_scc1 L_G_p0
    s_mov_b64 exec, 0xfffffff
    global_load_dword v230, v22, s[16:17]
    s_mov_b64 exec, -1
L_G_p0:
    s_cmp_eq_u32 s40, 1
    s_cbranch_scc0 L_G_go
    s_mov_b32 s51, s49
    s_mov_b32 s49, 229376
L_G_wo:
    buffer_load_dwordx4 v16, s[32:35], s47 offen  lds
    s_add_u32 m0, m0, 4352
    s_add_u32 s47, s47, s48
    s_cmp_lt_u32 s47, s49
    s_cbranch_scc1 L_G_wo
    s_mov_b32 s49, s51
L_G_go:
    s_cmp_lg_u32 s7, 0
    s_cbranch_scc1 SL_G_b1
    s_branch L_G_b1
.p2align 12
PC0:
    s_setpc_b64 s[88:89]
L_C_top:
    s_sleep 2
    buffer_load_dwordx4 v[132:135], v13, s[28:31], s6 offen sc1
    buffer_load_dwordx4 v[136:139], v13, s[28:31], s6 offen offset:1024 sc1
    s_nop 15
    s_nop 7
.p2align 6
L_C_po:
    buffer_load_dwordx4 v[132:135], v13, s[28:31], s6 offen sc1
    buffer_load_dwordx4 v[136:139], v13, s[28:31], s6 offen offset:1024 sc1
    s_add_u32 s53, s53, 1
    s_cmp_gt_u32 s53, 1048576
    s_cbranch_scc1 L_exit
    s_waitcnt vmcnt(2)
L_C_pow:
    v_bitop3_b32 v156, v133, v135, s97 bitop3:0x96
    v_bitop3_b32 v157, v137, v139, s97 bitop3:0x96
    v_xor_b32 v148, s42, v133
    v_xor_b32 v149, s42, v137
    v_max_f32 v142, v148, v149
    v_cmp_ne_u64 vcc, 0, v[156:157]
    v_lshlrev_b32 v156, 16, v132
    v_max_f32_dpp v142, v142, v142 row_ror:4 row_mask:0xf bank_mask:0xf
    v_and_b32 v157, 0xffff0000, v132
    v_lshlrev_b32 v158, 16, v134
    v_max_f32_dpp v143, v142, v142 row_ror:8 row_mask:0xf bank_mask:0xf
    v_max_f32_dpp v142, v142, v142 row_ror:8 row_mask:0xf bank_mask:0xf
    s_cbranch_vccnz L_C_po
    v_and_b32 v159, 0xffff0000, v134
    v_permlane16_swap_b32 v142, v143
    v_max_f32 v144, v142, v143
    v_max_f32 v142, v142, v143
    v_lshlrev_b32 v160, 16, v136
    v_and_b32 v161, 0xffff0000, v136
    v_permlane32_swap_b32 v142, v144
    v_max_f32 v142, v142, v144
    v_sub_f32 v148, v148, v142
    v_sub_f32 v149, v149, v142
    v_exp_f32 v148, v148
    v_exp_f32 v149, v149
    v_lshlrev_b32 v162, 16, v138
    v_pk_mul_f32 v[152:153], v[156:157], v[148:149] op_sel_hi:[1,0]
    v_add_f32 v144, v148, v149
    v_pk_fma_f32 v[152:153], v[160:161], v[148:149], v[152:153] op_sel:[0,1,0]
    v_and_b32 v163, 0xffff0000, v138
    v_pk_mul_f32 v[154:155], v[158:159], v[148:149] op_sel_hi:[1,0]
    v_add_f32_dpp v144, v144, v144 row_ror:4 row_mask:0xf bank_mask:0xf
    v_pk_fma_f32 v[154:155], v[162:163], v[148:149], v[154:155] op_sel:[0,1,0]
    v_permlane32_swap_b32 v152, v153
    v_add_f32_dpp v143, v144, v144 row_ror:8 row_mask:0xf bank_mask:0xf
    v_add_f32_dpp v144, v144, v144 row_ror:8 row_mask:0xf bank_mask:0xf
    v_permlane32_swap_b32 v154, v155
    v_add_f32 v152, v152, v153
    v_add_f32 v154, v154, v155
    v_permlane16_swap_b32 v144, v143
    v_add_f32 v142, v144, v143
    v_permlane16_swap_b32 v152, v154
    v_add_f32 v144, v144, v143
    v_add_f32 v152, v152, v154
    s_nop 0
    v_permlane32_swap_b32 v144, v142
    v_add_f32_dpp v152, v152, v152 row_ror:4 row_mask:0xf bank_mask:0xf
    v_add_f32 v144, v144, v142
    v_rcp_f32 v144, v144
    v_add_f32_dpp v152, v152, v152 row_ror:8 row_mask:0xf bank_mask:0xf
    v_mul_f32 v152, v152, v144
    v_cvt_pk_bf16_f32 v152, v152, v152
    buffer_store_short v152, v14, s[28:31], s6 offen
    s_cmp_lg_u32 s26, 0
    s_cbranch_scc1 L_G_end
    s_branch L_G_ba2
L_G_b1:
L_G_b2:
    s_barrier
    s_barrier
    s_cmp_lt_u32 s50, 32
    s_cbranch_scc1 L_C_top
    s_cmp_lg_u32 s26, 0
    s_cbranch_scc1 L_G_disp
    s_and_b32 s54, s40, 2
    s_cbranch_scc0 L_G_p8
    s_sleep 10
L_G_p8:
    s_cmp_eq_u32 s40, 3
    s_cbranch_scc0 L_G_p9
    s_mov_b32 exec_hi, 0
    global_load_dword v230, v23, s[20:21]
    s_mov_b64 exec, -1
L_G_p9:
    s_and_b32 s54, s40, 3
    s_cbranch_scc1 L_G_wf0
L_G_ba2:
    s_barrier
    s_add_u32 s54, s6, 73728
    s_cmp_lt_u32 s50, 32
    s_cbranch_scc0 L_G_np
    buffer_load_dwordx4 v[132:135], v13, s[28:31], s54 offen sc1
    buffer_load_dwordx4 v[136:139], v13, s[28:31], s54 offen offset:1024 sc1
L_G_np:
    s_cmp_lg_u32 s40, 4
    s_cbranch_scc1 L_G_wf
    buffer_load_dword v230, v24, s[28:31], s54 offen sc1
    s_branch L_G_fin
L_G_wf0:
    s_and_b32 s54, s40, 1
    s_cbranch_scc0 L_G_wf1
    s_mov_b64 exec, 0xff
    v_mov_b32 v21, 0
    buffer_atomic_or v21, v15, s[28:31], 0 offen sc0
    s_mov_b64 exec, -1
L_G_wf1:
    s_cmp_lt_u32 s47, s49
    s_cbranch_scc0 L_G_wf2
L_G_wf:
    buffer_load_dwordx4 v16, s[32:35], s47 offen  lds
    s_add_u32 m0, m0, 4352
    s_add_u32 s47, s47, s48
    s_cmp_lt_u32 s47, s49
    s_cbranch_scc1 L_G_wf
L_G_wf2:
L_G_m:
    s_waitcnt vmcnt(0)
    v_lshlrev_b32 v124, 16, v124
    s_barrier
    s_sub_u32 s54, s40, 1
    s_cmp_lt_u32 s54, 2
    s_cbranch_scc0 L_G_tr
    buffer_load_dwordx4 v[96:99], v3, s[28:31], s46 offen sc1
L_G_tr:
    ds_read_b64_tr_b16 v[32:33], v7 offset:0
    ds_read_b64_tr_b16 v[34:35], v7 offset:256
    ds_read_b64_tr_b16 v[36:37], v8 offset:0
    ds_read_b64_tr_b16 v[38:39], v8 offset:256
    v_mov_b64 v[152:153], 0
    v_mov_b64 v[154:155], 0
    v_mov_b32 v156, v5
    v_mov_b32 v157, v5
    v_mov_b32 v158, v5
    v_mov_b32 v159, v5
    ds_read_b64_tr_b16 v[40:41], v7 offset:2176
    ds_read_b64_tr_b16 v[42:43], v7 offset:2432
    ds_read_b64_tr_b16 v[44:45], v8 offset:2176
    ds_read_b64_tr_b16 v[46:47], v8 offset:2432
    ds_read_b64_tr_b16 v[48:49], v7 offset:4352
    ds_read_b64_tr_b16 v[50:51], v7 offset:4608
    ds_read_b64_tr_b16 v[52:53], v8 offset:4352
    ds_read_b64_tr_b16 v[54:55], v8 offset:4608
    ds_read_b64_tr_b16 v[56:57], v7 offset:6528
    ds_read_b64_tr_b16 v[58:59], v7 offset:6784
    ds_read_b64_tr_b16 v[60:61], v8 offset:6528
    ds_read_b64_tr_b16 v[62:63], v8 offset:6784
    s_waitcnt lgkmcnt(12)
    v_smfmac_f32_16x16x64_bf16 v[152:155], v[156:159], v[32:39], v4
    ds_read_b64_tr_b16 v[64:65], v7 offset:8704
    ds_read_b64_tr_b16 v[66:67], v7 offset:8960
    ds_read_b64_tr_b16 v[68:69], v8 offset:8704
    ds_read_b64_tr_b16 v[70:71], v8 offset:8960
    s_waitcnt lgkmcnt(12)
    v_smfmac_f32_16x16x64_bf16 v[152:155], v[156:159], v[40:47], v4
    ds_read_b64_tr_b16 v[72:73], v7 offset:10880
    ds_read_b64_tr_b16 v[74:75], v7 offset:11136
    ds_read_b64_tr_b16 v[76:77], v8 offset:10880
    ds_read_b64_tr_b16 v[78:79], v8 offset:11136
    s_waitcnt lgkmcnt(12)
    v_smfmac_f32_16x16x64_bf16 v[152:155], v[156:159], v[48:55], v4
    ds_read_b64_tr_b16 v[80:81], v7 offset:13056
    ds_read_b64_tr_b16 v[82:83], v7 offset:13312
    ds_read_b64_tr_b16 v[84:85], v8 offset:13056
    ds_read_b64_tr_b16 v[86:87], v8 offset:13312
    s_waitcnt lgkmcnt(12)
    v_smfmac_f32_16x16x64_bf16 v[152:155], v[156:159], v[56:63], v4
    ds_read_b64_tr_b16 v[88:89], v7 offset:15232
    ds_read_b64_tr_b16 v[90:91], v7 offset:15488
    ds_read_b64_tr_b16 v[92:93], v8 offset:15232
    ds_read_b64_tr_b16 v[94:95], v8 offset:15488
    s_waitcnt lgkmcnt(12)
    v_smfmac_f32_16x16x64_bf16 v[152:155], v[156:159], v[64:71], v4
    s_cmp_eq_u32 s40, 1
    s_cbranch_scc1 L_O_poll
L_G_tr2:
    s_waitcnt lgkmcnt(8)
    v_smfmac_f32_16x16x64_bf16 v[152:155], v[156:159], v[72:79], v4
    s_waitcnt lgkmcnt(4)
    v_smfmac_f32_16x16x64_bf16 v[152:155], v[156:159], v[80:87], v4
    s_cmp_eq_u32 s40, 2
    s_cselect_b32 s54, s41, 99
    s_cmp_lt_u32 s54, 14
    s_nop 4
    v_add_f32 v114, v152, v153
    s_cbranch_scc1 L_X_poll
L_G_disp:
    s_cmp_eq_u32 s40, 1
    s_cbranch_scc1 L_O_go
    s_cmp_eq_u32 s40, 3
    s_cbranch_scc1 L_H_go
    s_cmp_eq_u32 s40, 2
    s_cbranch_scc0 L_G_d2
    s_cmp_lt_u32 s41, 14
    s_cbranch_scc0 L_G_fin
    s_cmp_lg_u32 s26, 0
    s_cbranch_scc0 L_X_poll0
    s_branch L_X_poll0
PC1:
    s_setpc_b64 s[88:89]
L_G_d2:
    s_cmp_lg_u32 s26, 0
    s_cbranch_scc1 L_G_end
    s_cmp_eq_u32 s40, 0
    s_cbranch_scc0 L_G_fin
    v_mov_b32 v17, 68608
L_Q_gate:
    buffer_load_dword v18, v17, s[28:31], s6 offen sc1
    s_add_u32 s53, s53, 1
    s_cmp_gt_u32 s53, 1048576
    s_cbranch_scc1 L_exit
    s_sleep 2
    s_waitcnt vmcnt(0)
    v_cmp_eq_u32 vcc, s52, v18
    s_cbranch_vccnz L_Q_gate
L_X_poll0:
    buffer_load_dwordx4 v[96:99], v3, s[28:31], s46 offen sc1
    s_nop 15
    s_nop 7
.p2align 6
L_X_poll:
    buffer_load_dwordx4 v[96:99], v3, s[28:31], s46 offen sc1
    s_sub_u32 s45, s45, 1
    s_cbranch_scc1 L_X_poll_esc
L_X_poll_z:
    v_mov_b64 v[108:109], 0
    v_mov_b64 v[110:111], 0
    s_waitcnt vmcnt(1) lgkmcnt(0)
L_X_x:
    v_dot2_f32_bf16 v113, v96, v96, 0
    v_dot2_f32_bf16 v113, v97, v97, v113
    v_dot2_f32_bf16 v113, v98, v98, v113
    v_dot2_f32_bf16 v113, v99, v99, v113
    v_smfmac_f32_16x16x64_bf16 v[108:111], v[96:99], v[32:39], v4
    v_dot2_f32_bf16 v112, v96, v5, 0
    v_dot2_f32_bf16 v112, v97, v5, v112
    v_cmp_class_f32 vcc, v113, s27
    v_dot2_f32_bf16 v112, v98, v5, v112
    v_dot2_f32_bf16 v112, v99, v5, v112
    v_mov_b32_dpp v104, v96 row_shl:2 row_mask:0xf bank_mask:0xf
    v_mov_b32_dpp v105, v97 row_shl:2 row_mask:0xf bank_mask:0xf
    v_mov_b32_dpp v106, v98 row_shl:2 row_mask:0xf bank_mask:0xf
    v_mov_b32_dpp v107, v99 row_shl:2 row_mask:0xf bank_mask:0xf
    s_cbranch_vccnz L_X_poll
    v_permlane32_swap_b32 v112, v113
    v_add_f32 v112, v112, v113
    v_smfmac_f32_16x16x64_bf16 v[108:111], v[104:107], v[40:47], v4
    v_mov_b32_dpp v100, v96 row_shl:4 row_mask:0xf bank_mask:0xf
    v_add_f32_dpp v112, v112, v112 row_ror:8 row_mask:0xf bank_mask:0xf
    v_mov_b32_dpp v101, v97 row_shl:4 row_mask:0xf bank_mask:0xf
    v_mov_b32_dpp v102, v98 row_shl:4 row_mask:0xf bank_mask:0xf
    v_add_f32_dpp v112, v112, v112 row_ror:4 row_mask:0xf bank_mask:0xf
    v_mov_b32_dpp v103, v99 row_shl:4 row_mask:0xf bank_mask:0xf
    v_mov_b32_dpp v104, v96 row_shl:6 row_mask:0xf bank_mask:0xf
    v_add_f32_dpp v112, v112, v112 row_ror:2 row_mask:0xf bank_mask:0xf
    v_smfmac_f32_16x16x64_bf16 v[108:111], v[100:103], v[48:55], v4
    v_mov_b32_dpp v105, v97 row_shl:6 row_mask:0xf bank_mask:0xf
    v_add_f32_dpp v112, v112, v112 row_ror:1 row_mask:0xf bank_mask:0xf
    v_mov_b32_dpp v106, v98 row_shl:6 row_mask:0xf bank_mask:0xf
    v_mov_b32_dpp v107, v99 row_shl:6 row_mask:0xf bank_mask:0xf
    v_add_f32_dpp v112, v112, v112 row_bcast:15 row_mask:0xa bank_mask:0xf
    v_mov_b32_dpp v100, v96 row_shl:8 row_mask:0xf bank_mask:0xf
    v_smfmac_f32_16x16x64_bf16 v[108:111], v[104:107], v[56:63], v4
    v_fma_f32 v112, v112, v140, v141
    v_mov_b32_dpp v101, v97 row_shl:8 row_mask:0xf bank_mask:0xf
    v_readlane_b32 s98, v112, 16
    v_readlane_b32 s99, v112, 48
    v_mov_b32_dpp v102, v98 row_shl:8 row_mask:0xf bank_mask:0xf
    v_mov_b32_dpp v103, v99 row_shl:8 row_mask:0xf bank_mask:0xf
    v_mov_b32_dpp v104, v96 row_shl:10 row_mask:0xf bank_mask:0xf
    v_mov_b32_dpp v105, v97 row_shl:10 row_mask:0xf bank_mask:0xf
    v_smfmac_f32_16x16x64_bf16 v[108:111], v[100:103], v[64:71], v4
    v_mov_b32_dpp v106, v98 row_shl:10 row_mask:0xf bank_mask:0xf
    v_mov_b32_dpp v107, v99 row_shl:10 row_mask:0xf bank_mask:0xf
    v_mov_b32_dpp v100, v96 row_shl:12 row_mask:0xf bank_mask:0xf
    v_mov_b32_dpp v101, v97 row_shl:12 row_mask:0xf bank_mask:0xf
    v_smfmac_f32_16x16x64_bf16 v[108:111], v[104:107], v[72:79], v4
    v_mov_b32_dpp v102, v98 row_shl:12 row_mask:0xf bank_mask:0xf
    v_mov_b32_dpp v103, v99 row_shl:12 row_mask:0xf bank_mask:0xf
    v_mov_b32 v117, s98
    s_cmp_eq_u32 s40, 0
    v_smfmac_f32_16x16x64_bf16 v[108:111], v[100:103], v[80:87], v4
    s_cbranch_scc1 L_X_eq
    v_fma_f32 v118, -v117, v117, s99
    v_max_f32 v119, s96, v118
    v_rsq_f32 v119, v119
    v_mul_f32 v117, v117, v114
    v_mul_f32 v117, v117, v119
    v_mul_f32 v120, 0xbfb8aa3b, v119
    v_mul_f32 v121, 0x3fb8aa3b, v117
    v_add_f32 v116, v108, v109
    v_fma_f32 v120, v116, v120, v121
    v_exp_f32 v120, v120
    v_fma_f32 v116, v116, v119, -v117
    v_add_f32 v120, 1.0, v120
    v_rcp_f32 v120, v120
    s_nop 0
    v_mul_f32 v116, v116, v120
    v_cvt_pk_bf16_f32 v116, v116, v116
    buffer_store_short v116, v6, s[28:31], s6 offen
    s_branch L_G_fin
L_X_eq:
    v_fma_f32 v118, -v117, v117, s99
    v_max_f32 v119, s96, v118
    v_rsq_f32 v119, v119
    v_mul_f32 v117, v117, v114
    v_mul_f32 v117, v117, v119
    s_nop 1
    v_add_f32 v116, v108, v109
    v_fma_f32 v116, v116, v119, -v117
    v_cvt_pk_bf16_f32 v117, v116, v116
    buffer_store_short v117, v6, s[28:31], s6 offen
    s_barrier
    s_branch L_G_next
L_H_go:
    s_mov_b64 exec, 0xff
    s_branch L_H_rd2
PC2:
    s_setpc_b64 s[88:89]
L_H_rd:
    v_mov_b32 v21, 0
    buffer_atomic_or v21, v15, s[28:31], 0 offen sc0
    s_add_u32 s53, s53, 1
    s_cmp_gt_u32 s53, 1048576
    s_cbranch_scc1 L_exit
    s_waitcnt vmcnt(0)
L_H_rd2:
    v_cmp_ne_u32 vcc, s42, v21
    s_cbranch_vccnz L_H_rd
    s_mov_b64 exec, -1
    s_add_u32 s51, s6, 69632
L_H_gate:
    buffer_load_ushort v115, v11, s[28:31], s51 offen sc1
    s_add_u32 s53, s53, 1
    s_cmp_gt_u32 s53, 1048576
    s_cbranch_scc1 L_exit
    s_sleep 1
    s_waitcnt vmcnt(0)
    v_cmp_eq_u32 vcc, 0xffa5, v115
    s_cbranch_vccnz L_H_gate
    v_lshlrev_b32 v124, 16, v115
L_H_poll0:
    buffer_load_dwordx4 v[96:99], v3, s[28:31], s46 offen sc1
    s_nop 15
    s_nop 7
.p2align 6
L_H_poll:
    buffer_load_dwordx4 v[96:99], v3, s[28:31], s46 offen sc1
    s_sub_u32 s45, s45, 1
    s_cbranch_scc1 L_H_poll_esc
L_H_poll_z:
    v_mov_b64 v[108:109], 0
    v_mov_b64 v[110:111], 0
    s_waitcnt vmcnt(1) lgkmcnt(0)
L_H_x:
    v_dot2_f32_bf16 v113, v96, v96, 0
    v_dot2_f32_bf16 v113, v97, v97, v113
    v_dot2_f32_bf16 v113, v98, v98, v113
    v_dot2_f32_bf16 v113, v99, v99, v113
    v_smfmac_f32_16x16x64_bf16 v[108:111], v[96:99], v[32:39], v4
    v_mov_b32_dpp v104, v96 row_shl:2 row_mask:0xf bank_mask:0xf
    v_mov_b32_dpp v105, v97 row_shl:2 row_mask:0xf bank_mask:0xf
    v_cmp_class_f32 vcc, v113, s27
    v_mov_b32_dpp v106, v98 row_shl:2 row_mask:0xf bank_mask:0xf
    v_mov_b32_dpp v107, v99 row_shl:2 row_mask:0xf bank_mask:0xf
    v_mov_b32_dpp v100, v96 row_shl:4 row_mask:0xf bank_mask:0xf
    v_mov_b32_dpp v101, v97 row_shl:4 row_mask:0xf bank_mask:0xf
    v_mov_b32_dpp v102, v98 row_shl:4 row_mask:0xf bank_mask:0xf
    v_mov_b32_dpp v103, v99 row_shl:4 row_mask:0xf bank_mask:0xf
    s_cbranch_vccnz L_H_poll
    v_smfmac_f32_16x16x64_bf16 v[108:111], v[104:107], v[40:47], v4
    v_mov_b32_dpp v104, v96 row_shl:6 row_mask:0xf bank_mask:0xf
    v_mov_b32_dpp v105, v97 row_shl:6 row_mask:0xf bank_mask:0xf
    v_mov_b32_dpp v106, v98 row_shl:6 row_mask:0xf bank_mask:0xf
    v_mov_b32_dpp v107, v99 row_shl:6 row_mask:0xf bank_mask:0xf
    v_smfmac_f32_16x16x64_bf16 v[108:111], v[100:103], v[48:55], v4
    s_nop 0
    v_smfmac_f32_16x16x64_bf16 v[108:111], v[104:107], v[56:63], v4
    s_cmp_lg_u32 s26, 0
    s_nop 6
    v_add_f32 v116, v108, v109
    buffer_atomic_swap v116, v6, s[28:31], s44 offen
L_H_sk:
    s_cbranch_scc0 L_R_go
    s_mov_b64 exec, 1
    global_atomic_add v146, v125, v147, s[28:29] offset:64 sc0
    s_mov_b64 exec, -1
L_Z_poll:
    global_atomic_or_x2 v[122:123], v125, v[126:127], s[28:29] sc0
    s_add_u32 s53, s53, 1
    s_cmp_gt_u32 s53, 1048576
    s_cbranch_scc1 L_exit
    s_waitcnt vmcnt(0)
L_Z_x:
    v_readfirstlane_b32 s51, v146
    v_cmp_eq_u32 vcc, s52, v122
    v_cmp_eq_u32 s[54:55], s52, v123
    v_add_f32_dpp v116, v122, v122 row_ror:8 row_mask:0xf bank_mask:0xf
    v_add_f32_dpp v117, v123, v123 row_ror:8 row_mask:0xf bank_mask:0xf
    s_cmp_lg_u32 s51, 4289068972
    s_cbranch_scc1 L_Z_no
L_Z_y:
    v_permlane32_swap_b32 v116, v117
    v_add_f32 v116, v116, v117
    v_add_f32 v117, v116, v124
    s_or_b64 vcc, vcc, s[54:55]
    s_cbranch_scc1 L_Z_poll
    v_permlane16_swap_b32 v117, v116
    v_add_f32 v116, v116, v117
    v_cvt_pk_bf16_f32 v116, v116, v116
    buffer_store_short v116, v10, s[36:39], 0 offen
    s_branch L_Z_end
L_Z_no:
    s_branch L_Z_end
L_O_go:
L_O_poll0:
    buffer_load_dwordx4 v[96:99], v3, s[28:31], s46 offen sc1
    s_nop 15
    s_nop 7
.p2align 6
L_O_poll:
    buffer_load_dwordx4 v[96:99], v3, s[28:31], s46 offen sc1
    s_sub_u32 s45, s45, 1
    s_cbranch_scc1 L_O_poll_esc
L_O_poll_z:
    v_mov_b64 v[108:109], 0
    v_mov_b64 v[110:111], 0
    s_waitcnt vmcnt(1) lgkmcnt(0)
L_O_x:
    v_dot2_f32_bf16 v113, v96, v96, 0
    v_dot2_f32_bf16 v113, v97, v97, v113
    v_dot2_f32_bf16 v113, v98, v98, v113
    v_dot2_f32_bf16 v113, v99, v99, v113
    v_smfmac_f32_16x16x64_bf16 v[108:111], v[96:99], v[32:39], v4
    v_mov_b32_dpp v104, v96 row_shl:2 row_mask:0xf bank_mask:0xf
    v_mov_b32_dpp v105, v97 row_shl:2 row_mask:0xf bank_mask:0xf
    v_cmp_class_f32 vcc, v113, s27
    v_mov_b32_dpp v106, v98 row_shl:2 row_mask:0xf bank_mask:0xf
    v_mov_b32_dpp v107, v99 row_shl:2 row_mask:0xf bank_mask:0xf
    v_mov_b32_dpp v100, v96 row_shl:4 row_mask:0xf bank_mask:0xf
    v_mov_b32_dpp v101, v97 row_shl:4 row_mask:0xf bank_mask:0xf
    v_mov_b32_dpp v102, v98 row_shl:4 row_mask:0xf bank_mask:0xf
    v_mov_b32_dpp v103, v99 row_shl:4 row_mask:0xf bank_mask:0xf
    s_cbranch_vccnz L_O_poll
    v_smfmac_f32_16x16x64_bf16 v[108:111], v[104:107], v[40:47], v4
    v_mov_b32_dpp v104, v96 row_shl:6 row_mask:0xf bank_mask:0xf
    v_mov_b32_dpp v105, v97 row_shl:6 row_mask:0xf bank_mask:0xf
    v_mov_b32_dpp v106, v98 row_shl:6 row_mask:0xf bank_mask:0xf
    v_mov_b32_dpp v107, v99 row_shl:6 row_mask:0xf bank_mask:0xf
    v_smfmac_f32_16x16x64_bf16 v[108:111], v[100:103], v[48:55], v4
    v_mov_b32_dpp v100, v96 row_shl:8 row_mask:0xf bank_mask:0xf
    v_mov_b32_dpp v101, v97 row_shl:8 row_mask:0xf bank_mask:0xf
    v_mov_b32_dpp v102, v98 row_shl:8 row_mask:0xf bank_mask:0xf
    v_mov_b32_dpp v103, v99 row_shl:8 row_mask:0xf bank_mask:0xf
    v_smfmac_f32_16x16x64_bf16 v[108:111], v[104:107], v[56:63], v4
    v_mov_b32_dpp v104, v96 row_shl:10 row_mask:0xf bank_mask:0xf
    v_mov_b32_dpp v105, v97 row_shl:10 row_mask:0xf bank_mask:0xf
    v_mov_b32_dpp v106, v98 row_shl:10 row_mask:0xf bank_mask:0xf
    v_mov_b32_dpp v107, v99 row_shl:10 row_mask:0xf bank_mask:0xf
    v_smfmac_f32_16x16x64_bf16 v[108:111], v[100:103], v[64:71], v4
    v_mov_b32_dpp v100, v96 row_shl:12 row_mask:0xf bank_mask:0xf
    v_mov_b32_dpp v101, v97 row_shl:12 row_mask:0xf bank_mask:0xf
    v_mov_b32_dpp v102, v98 row_shl:12 row_mask:0xf bank_mask:0xf
    v_mov_b32_dpp v103, v99 row_shl:12 row_mask:0xf bank_mask:0xf
    v_smfmac_f32_16x16x64_bf16 v[108:111], v[104:107], v[72:79], v4
    v_mov_b32_dpp v104, v96 row_shl:14 row_mask:0xf bank_mask:0xf
    v_mov_b32_dpp v105, v97 row_shl:14 row_mask:0xf bank_mask:0xf
    v_mov_b32_dpp v106, v98 row_shl:14 row_mask:0xf bank_mask:0xf
    v_mov_b32_dpp v107, v99 row_shl:14 row_mask:0xf bank_mask:0xf
    v_smfmac_f32_16x16x64_bf16 v[108:111], v[100:103], v[80:87], v4
    s_nop 0
    v_smfmac_f32_16x16x64_bf16 v[108:111], v[104:107], v[88:95], v4
    s_nop 7
    v_add_f32 v116, v108, v109
    buffer_atomic_swap v116, v6, s[28:31], s44 offen
L_O_sk:
L_R_go:
    s_barrier
    v_cmp_ne_u32 vcc, s42, v21
    v_add_u32 v125, s44, v9
    v_mov_b64 v[126:127], 0
    s_and_b32 s54, vcc_lo, 0xff
    s_cbranch_scc1 L_R_rd
L_R_rdok:
    s_sleep 3
    global_atomic_or_x2 v[122:123], v125, v[126:127], s[28:29] sc0
    s_nop 15
    s_nop 15
    s_nop 15
    s_nop 11
    s_branch L_R_p1
PC3:
    s_setpc_b64 s[88:89]
.p2align 6
L_R_poll:
L_R_p1:
    global_atomic_or_x2 v[122:123], v125, v[126:127], s[28:29] sc0
    s_add_u32 s53, s53, 1
    s_cmp_gt_u32 s53, 1048576
    s_cbranch_scc1 L_exit
    s_waitcnt vmcnt(1)
L_R_x:
    v_cmp_eq_u32 vcc, s52, v122
    v_cmp_eq_u32 s[54:55], s52, v123
    v_add_f32_dpp v116, v122, v122 row_ror:8 row_mask:0xf bank_mask:0xf
    v_add_f32_dpp v117, v123, v123 row_ror:8 row_mask:0xf bank_mask:0xf
    s_nop 1
    v_permlane32_swap_b32 v116, v117
    v_add_f32 v116, v116, v117
    v_add_f32 v117, v116, v124
    s_or_b64 vcc, vcc, s[54:55]
    s_cbranch_scc1 L_R_poll
    v_permlane16_swap_b32 v117, v116
    v_add_f32 v116, v116, v117
    v_cvt_pk_bf16_f32 v116, v116, v116
    buffer_store_short v116, v10, s[36:39], s56 offen
    s_branch L_G_fin
L_Z_end:
L_G_end:
L_G_end2:
    s_endpgm
L_G_fin:
    s_cmp_lg_u32 s26, 0
    s_cbranch_scc1 L_G_end
    s_barrier
    s_cmp_eq_u32 s40, 1
    s_cselect_b32 s54, 3, s3
    s_cmp_eq_u32 s54, 3
    s_cbranch_scc0 L_G_next
L_G_x2:
    buffer_load_ushort v115, v11, s[28:31], s57 offen sc1
    s_add_u32 s53, s53, 1
    s_cmp_gt_u32 s53, 1048576
    s_cbranch_scc1 L_exit
    s_sleep 1
    s_waitcnt vmcnt(0)
    v_cmp_eq_u32 vcc, 0xffa5, v115
    s_cbranch_vccnz L_G_x2
    v_lshlrev_b32 v124, 16, v115
L_G_next:
    s_cmp_eq_u32 s3, 3
    s_cbranch_scc0 L_G_nb
    v_lshlrev_b32 v27, 4, v0
    v_add_u32 v26, 145408, v27
    v_add_u32 v27, 144384, v27
    s_mov_b32 s27, 3
L_Q_poll0:
    buffer_load_dwordx4 v[128:131], v26, s[28:31], s6 offen sc1
    s_nop 15
    s_nop 7
    buffer_load_dwordx4 v[128:131], v26, s[28:31], s6 offen sc1
.p2align 7
L_Q_poll:
    s_waitcnt vmcnt(1) lgkmcnt(0)
    v_dot2_f32_bf16 v113, v128, v128, 0
    v_dot2_f32_bf16 v113, v129, v129, v113
    v_dot2_f32_bf16 v113, v130, v130, v113
    v_dot2_f32_bf16 v113, v131, v131, v113
    ds_write_b128 v27, v[128:131]
    buffer_load_dwordx4 v[128:131], v26, s[28:31], s6 offen sc1
    s_sub_u32 s45, s45, 1
    s_cbranch_scc1 L_Q_poll_esc
    v_cmp_class_f32 vcc, v113, s27
    s_cbranch_vccnz L_Q_poll
    s_waitcnt lgkmcnt(0)
L_G_nb:
    s_barrier
    s_mov_b32 s27, 3
    s_mov_b32 s26, 1
    s_add_u32 s6, s6, 73728
    s_add_u32 s44, s44, 0x10000
    s_add_u32 s46, s46, 73728
    s_add_u32 s56, s56, 73728
    s_cmp_eq_u32 s40, 3
    s_cbranch_scc0 L_G_e2
    s_mov_b32 s36, s24
    s_mov_b32 s37, s25
    s_mov_b32 s38, 896
    v_add_u32 v125, s44, v9
    v_mov_b32 v147, 1
    s_or_b32 s54, s41, s4
    s_cbranch_scc1 L_G_e2
    v_mov_b32 v17, 0
    v_mov_b32 v18, s42
    s_mov_b64 exec, 1
    buffer_store_dword v18, v17, s[28:31], 0 offen sc1
    s_mov_b64 exec, -1
L_G_e2:
    s_cmp_lt_u32 s50, 32
    s_cbranch_scc1 L_G_b1
    s_and_b32 s54, s40, 3
    s_cbranch_scc1 L_G_b1
    s_branch L_G_end2
L_X_poll_esc:
    s_movk_i32 s45, 0xfff
    s_add_u32 s53, s53, 0x1000
    s_cmp_gt_u32 s53, 1048576
    s_cbranch_scc1 L_exit
    s_waitcnt vmcnt(0) lgkmcnt(0)
    s_mov_b64 s[54:55], 0
    v_and_b32 v120, 0xffff, v96
    v_cmp_eq_u32 vcc, 0xffa5, v120
    s_or_b64 s[54:55], s[54:55], vcc
    v_lshrrev_b32 v120, 16, v96
    v_cmp_eq_u32 vcc, 0xffa5, v120
    s_or_b64 s[54:55], s[54:55], vcc
    v_and_b32 v120, 0xffff, v97
    v_cmp_eq_u32 vcc, 0xffa5, v120
    s_or_b64 s[54:55], s[54:55], vcc
    v_lshrrev_b32 v120, 16, v97
    v_cmp_eq_u32 vcc, 0xffa5, v120
    s_or_b64 s[54:55], s[54:55], vcc
    v_and_b32 v120, 0xffff, v98
    v_cmp_eq_u32 vcc, 0xffa5, v120
    s_or_b64 s[54:55], s[54:55], vcc
    v_lshrrev_b32 v120, 16, v98
    v_cmp_eq_u32 vcc, 0xffa5, v120
    s_or_b64 s[54:55], s[54:55], vcc
    v_and_b32 v120, 0xffff, v99
    v_cmp_eq_u32 vcc, 0xffa5, v120
    s_or_b64 s[54:55], s[54:55], vcc
    v_lshrrev_b32 v120, 16, v99
    v_cmp_eq_u32 vcc, 0xffa5, v120
    s_or_b64 s[54:55], s[54:55], vcc
    s_cbranch_scc1 L_X_poll0
    s_mov_b32 s27, 0
    s_branch L_X_poll_z
L_H_poll_esc:
    s_movk_i32 s45, 0xfff
    s_add_u32 s53, s53, 0x1000
    s_cmp_gt_u32 s53, 1048576
    s_cbranch_scc1 L_exit
    s_waitcnt vmcnt(0) lgkmcnt(0)
    s_mov_b64 s[54:55], 0
    v_and_b32 v117, 0xffff, v96
    v_cmp_eq_u32 vcc, 0xffa5, v117
    s_or_b64 s[54:55], s[54:55], vcc
    v_lshrrev_b32 v117, 16, v96
    v_cmp_eq_u32 vcc, 0xffa5, v117
    s_or_b64 s[54:55], s[54:55], vcc
    v_and_b32 v117, 0xffff, v97
    v_cmp_eq_u32 vcc, 0xffa5, v117
    s_or_b64 s[54:55], s[54:55], vcc
    v_lshrrev_b32 v117, 16, v97
    v_cmp_eq_u32 vcc, 0xffa5, v117
    s_or_b64 s[54:55], s[54:55], vcc
    v_and_b32 v117, 0xffff, v98
    v_cmp_eq_u32 vcc, 0xffa5, v117
    s_or_b64 s[54:55], s[54:55], vcc
    v_lshrrev_b32 v117, 16, v98
    v_cmp_eq_u32 vcc, 0xffa5, v117
    s_or_b64 s[54:55], s[54:55], vcc
    v_and_b32 v117, 0xffff, v99
    v_cmp_eq_u32 vcc, 0xffa5, v117
    s_or_b64 s[54:55], s[54:55], vcc
    v_lshrrev_b32 v117, 16, v99
    v_cmp_eq_u32 vcc, 0xffa5, v117
    s_or_b64 s[54:55], s[54:55], vcc
    s_cbranch_scc1 L_H_poll0
    s_mov_b32 s27, 0
    s_branch L_H_poll_z
L_O_poll_esc:
    s_movk_i32 s45, 0xfff
    s_add_u32 s53, s53, 0x1000
    s_cmp_gt_u32 s53, 1048576
    s_cbranch_scc1 L_exit
    s_waitcnt vmcnt(0) lgkmcnt(0)
    s_mov_b64 s[54:55], 0
    v_and_b32 v117, 0xffff, v96
    v_cmp_eq_u32 vcc, 0xffa5, v117
    s_or_b64 s[54:55], s[54:55], vcc
    v_lshrrev_b32 v117, 16, v96
    v_cmp_eq_u32 vcc, 0xffa5, v117
    s_or_b64 s[54:55], s[54:55], vcc
    v_and_b32 v117, 0xffff, v97
    v_cmp_eq_u32 vcc, 0xffa5, v117
    s_or_b64 s[54:55], s[54:55], vcc
    v_lshrrev_b32 v117, 16, v97
    v_cmp_eq_u32 vcc, 0xffa5, v117
    s_or_b64 s[54:55], s[54:55], vcc
    v_and_b32 v117, 0xffff, v98
    v_cmp_eq_u32 vcc, 0xffa5, v117
    s_or_b64 s[54:55], s[54:55], vcc
    v_lshrrev_b32 v117, 16, v98
    v_cmp_eq_u32 vcc, 0xffa5, v117
    s_or_b64 s[54:55], s[54:55], vcc
    v_and_b32 v117, 0xffff, v99
    v_cmp_eq_u32 vcc, 0xffa5, v117
    s_or_b64 s[54:55], s[54:55], vcc
    v_lshrrev_b32 v117, 16, v99
    v_cmp_eq_u32 vcc, 0xffa5, v117
    s_or_b64 s[54:55], s[54:55], vcc
    s_cbranch_scc1 L_O_poll0
    s_mov_b32 s27, 0
    s_branch L_O_poll_z
L_R_rd:
    s_mov_b64 exec, 0xff
L_R_rd1:
    v_mov_b32 v21, 0
    buffer_atomic_or v21, v15, s[28:31], 0 offen sc0
    s_add_u32 s53, s53, 1
    s_cmp_gt_u32 s53, 1048576
    s_cbranch_scc1 L_exit
    s_waitcnt vmcnt(0)
    v_cmp_ne_u32 vcc, s42, v21
    s_cbranch_vccnz L_R_rd1
    s_mov_b64 exec, -1
    s_branch L_R_rdok
L_Q_poll_esc:
    s_movk_i32 s45, 0xfff
    s_add_u32 s53, s53, 0x1000
    s_cmp_gt_u32 s53, 1048576
    s_cbranch_scc1 L_exit
    s_waitcnt vmcnt(0) lgkmcnt(0)
    s_mov_b64 s[54:55], 0
    v_and_b32 v116, 0xffff, v128
    v_cmp_eq_u32 vcc, 0xffa5, v116
    s_or_b64 s[54:55], s[54:55], vcc
    v_lshrrev_b32 v116, 16, v128
    v_cmp_eq_u32 vcc, 0xffa5, v116
    s_or_b64 s[54:55], s[54:55], vcc
    v_and_b32 v116, 0xffff, v129
    v_cmp_eq_u32 vcc, 0xffa5, v116
    s_or_b64 s[54:55], s[54:55], vcc
    v_lshrrev_b32 v116, 16, v129
    v_cmp_eq_u32 vcc, 0xffa5, v116
    s_or_b64 s[54:55], s[54:55], vcc
    v_and_b32 v116, 0xffff, v130
    v_cmp_eq_u32 vcc, 0xffa5, v116
    s_or_b64 s[54:55], s[54:55], vcc
    v_lshrrev_b32 v116, 16, v130
    v_cmp_eq_u32 vcc, 0xffa5, v116
    s_or_b64 s[54:55], s[54:55], vcc
    v_and_b32 v116, 0xffff, v131
    v_cmp_eq_u32 vcc, 0xffa5, v116
    s_or_b64 s[54:55], s[54:55], vcc
    v_lshrrev_b32 v116, 16, v131
    v_cmp_eq_u32 vcc, 0xffa5, v116
    s_or_b64 s[54:55], s[54:55], vcc
    s_cbranch_scc1 L_Q_poll0
    s_mov_b32 s27, 0
    s_branch L_Q_poll
L_exit:
    s_endpgm
.p2align 6
SL_A_bq:
    s_barrier
SL_A_qk:
    ds_read_b128 v[160:163], v9 offset:0
    ds_read_b128 v[164:167], v9 offset:64
    ds_read_b128 v[168:171], v9 offset:128
    ds_read_b128 v[172:175], v9 offset:192
    s_waitcnt lgkmcnt(3)
    v_smfmac_f32_16x16x64_bf16 v[176:179], v[160:163], v[32:39], v5
    v_smfmac_f32_16x16x64_bf16 v[180:183], v[160:163], v[64:71], v5
    s_waitcnt lgkmcnt(2)
    v_smfmac_f32_16x16x64_bf16 v[176:179], v[164:167], v[40:47], v5
    v_smfmac_f32_16x16x64_bf16 v[180:183], v[164:167], v[72:79], v5
    s_waitcnt lgkmcnt(1)
    v_smfmac_f32_16x16x64_bf16 v[176:179], v[168:171], v[48:55], v5
    v_smfmac_f32_16x16x64_bf16 v[180:183], v[168:171], v[80:87], v5
    s_waitcnt lgkmcnt(0)
    v_smfmac_f32_16x16x64_bf16 v[176:179], v[172:175], v[56:63], v5
    v_smfmac_f32_16x16x64_bf16 v[180:183], v[172:175], v[88:95], v5
    s_nop 6
    v_pk_add_f32 v[192:193], v[176:177], v[178:179]
    v_pk_add_f32 v[194:195], v[180:181], v[182:183]
    v_max_f32 v196, v192, v194
    v_max_f32 v197, v193, v195
    v_cndmask_b32 v192, v192, v194, s[40:41]
    v_max_f32_dpp v196, v196, v196 row_ror:8 row_mask:0xf bank_mask:0xf
    v_max_f32_dpp v197, v197, v197 row_ror:8 row_mask:0xf bank_mask:0xf
    v_cndmask_b32 v193, v193, v195, s[40:41]
    v_max_f32_dpp v196, v196, v196 row_ror:4 row_mask:0xf bank_mask:0xf
    v_max_f32_dpp v197, v197, v197 row_ror:4 row_mask:0xf bank_mask:0xf
    v_mov_b32_dpp v192, v192 row_ror:8 row_mask:0xa bank_mask:0xf
    v_max_f32_dpp v196, v196, v196 row_ror:2 row_mask:0xf bank_mask:0xf
    v_max_f32_dpp v197, v197, v197 row_ror:2 row_mask:0xf bank_mask:0xf
    v_mov_b32_dpp v193, v193 row_ror:8 row_mask:0xa bank_mask:0xf
    v_max_f32_dpp v196, v196, v196 row_ror:1 row_mask:0xf bank_mask:0xf
    v_max_f32_dpp v197, v197, v197 row_ror:1 row_mask:0xf bank_mask:0xf
    v_pk_mul_f32 v[196:197], v[196:197], s[48:49]
    v_pk_fma_f32 v[192:193], v[192:193], s[48:49], v[196:197] neg_lo:[0,0,1] neg_hi:[0,0,1]
    v_exp_f32 v192, v192
    v_exp_f32 v193, v193
    v_cndmask_b32 v202, v196, v197, s[40:41]
    v_cvt_pk_bf16_f32 v200, v192, v193
    s_waitcnt vmcnt(8)
    v_permlane32_swap_b32 v192, v193
    v_and_b32_dpp v204, v200, v7 row_newbcast:0 row_mask:0xf bank_mask:0xf
    v_and_b32_dpp v205, v200, v8 row_newbcast:0 row_mask:0xf bank_mask:0xf
    v_and_b32_dpp v206, v200, v7 row_newbcast:1 row_mask:0xf bank_mask:0xf
    v_and_b32_dpp v207, v200, v8 row_newbcast:1 row_mask:0xf bank_mask:0xf
    v_add_f32 v203, v192, v193
    v_and_b32_dpp v208, v200, v7 row_newbcast:2 row_mask:0xf bank_mask:0xf
    v_smfmac_f32_16x16x64_bf16 v[184:187], v[204:207], v[96:103], v6
    v_add_f32_dpp v203, v203, v203 row_ror:8 row_mask:0xf bank_mask:0xf
    v_and_b32_dpp v209, v200, v8 row_newbcast:2 row_mask:0xf bank_mask:0xf
    v_smfmac_f32_16x16x64_bf16 v[188:191], v[204:207], v[104:111], v6
    v_add_f32_dpp v203, v203, v203 row_ror:4 row_mask:0xf bank_mask:0xf
    v_and_b32_dpp v210, v200, v7 row_newbcast:3 row_mask:0xf bank_mask:0xf
    v_and_b32_dpp v211, v200, v8 row_newbcast:3 row_mask:0xf bank_mask:0xf
    v_add_f32_dpp v203, v203, v203 row_ror:2 row_mask:0xf bank_mask:0xf
    v_and_b32_dpp v204, v200, v7 row_newbcast:4 row_mask:0xf bank_mask:0xf
    v_smfmac_f32_16x16x64_bf16 v[184:187], v[208:211], v[112:119], v6
    v_add_f32_dpp v203, v203, v203 row_ror:1 row_mask:0xf bank_mask:0xf
    v_and_b32_dpp v205, v200, v8 row_newbcast:4 row_mask:0xf bank_mask:0xf
    ds_write_b64 v13, v[202:203]
    v_smfmac_f32_16x16x64_bf16 v[188:191], v[208:211], v[120:127], v6
    v_and_b32_dpp v206, v200, v7 row_newbcast:5 row_mask:0xf bank_mask:0xf
    v_and_b32_dpp v207, v200, v8 row_newbcast:5 row_mask:0xf bank_mask:0xf
    v_and_b32_dpp v208, v200, v7 row_newbcast:6 row_mask:0xf bank_mask:0xf
    s_waitcnt vmcnt(4)
    v_smfmac_f32_16x16x64_bf16 v[184:187], v[204:207], v[128:135], v6
    v_and_b32_dpp v209, v200, v8 row_newbcast:6 row_mask:0xf bank_mask:0xf
    v_and_b32_dpp v210, v200, v7 row_newbcast:7 row_mask:0xf bank_mask:0xf
    v_smfmac_f32_16x16x64_bf16 v[188:191], v[204:207], v[136:143], v6
    v_and_b32_dpp v211, v200, v8 row_newbcast:7 row_mask:0xf bank_mask:0xf
    ds_read_b64 v[220:221], v14
    ds_read_b32 v222, v10
    s_waitcnt vmcnt(0)
    v_smfmac_f32_16x16x64_bf16 v[184:187], v[208:211], v[144:151], v6
    v_smfmac_f32_16x16x64_bf16 v[188:191], v[208:211], v[152:159], v6
SL_A_m:
    s_waitcnt lgkmcnt(0)
    v_max_f32_dpp v197, v220, v220 quad_perm:[1,0,3,2] row_mask:0xf bank_mask:0xf
    s_nop 1
    v_max_f32_dpp v197, v197, v197 quad_perm:[2,3,0,1] row_mask:0xf bank_mask:0xf
    v_sub_f32 v192, v220, v197
    v_exp_f32 v192, v192
    v_cvt_pk_bf16_f32 v212, v184, v185
    v_cvt_pk_bf16_f32 v213, v186, v187
    v_mul_f32 v192, v192, v221
    v_cvt_pk_bf16_f32 v214, v188, v189
    v_cvt_pk_bf16_f32 v215, v190, v191
    ds_write_b128 v11, v[212:215]
    v_add_f32_dpp v192, v192, v192 quad_perm:[1,0,3,2] row_mask:0xf bank_mask:0xf
    v_sub_f32 v224, v222, v197
    v_exp_f32 v224, v224
    v_add_f32_dpp v192, v192, v192 quad_perm:[2,3,0,1] row_mask:0xf bank_mask:0xf
    v_cmp_u_f32 vcc, v192, v192
    v_rcp_f32 v193, v192
    v_log_f32 v192, v192
    v_mul_f32 v224, v224, v193
    v_add_f32 v192, v192, v197
    v_cvt_pk_bf16_f32 v224, v224, v224
    s_cbranch_vccnz SL_A_mr
SL_A_mok:
    v_xor_b32 v217, v192, v19
    v_xor_b32 v219, v192, v20
    v_and_b32 v204, v224, v24
    v_and_b32 v205, v224, v25
    v_and_b32 v206, v224, v26
    v_and_b32 v207, v224, v27
    s_waitcnt lgkmcnt(0)
    s_barrier
SL_A_x:
    ds_read_b128 v[226:229], v12
    s_waitcnt lgkmcnt(0)
    v_mfma_f32_16x16x32_bf16 v[176:179], v[204:207], v[226:229], 0
    s_nop 7
    v_cvt_pk_bf16_f32 v216, v176, v177
    v_cvt_pk_bf16_f32 v218, v178, v179
    buffer_store_dwordx4 v[216:219], v15, s[28:31], s6 offen sc1
    s_barrier
    s_cmp_lg_u32 s26, 0
    s_cbranch_scc1 SL_A_end
    v_mov_b64 v[184:185], 0
    v_mov_b64 v[186:187], 0
    v_mov_b64 v[188:189], 0
    v_mov_b64 v[190:191], 0
    v_mov_b64 v[176:177], 0
    v_mov_b64 v[178:179], 0
    v_mov_b64 v[180:181], 0
    v_mov_b64 v[182:183], 0
    v_add_u32 v13, 64, v13
    v_add_u32 v14, 64, v14
    v_add_u32 v10, 64, v10
    s_add_u32 s6, s6, 73728
    s_mov_b32 s26, 1
    s_barrier
    s_barrier
    s_cmp_lt_u32 s5, 26
    s_cbranch_scc0 SL_A_bq
    s_sub_u32 s54, s5, 15
    s_cmp_lt_u32 s54, 4
    s_cbranch_scc1 SL_A_bq
    s_barrier
    s_branch SL_A_bq
SL_A_mr:
    v_cmp_eq_u32 vcc, s52, v221
    s_cbranch_vccz SL_A_mok
    ds_read_b64 v[220:221], v14
    ds_read_b32 v222, v10
    s_add_u32 s53, s53, 1
    s_cmp_gt_u32 s53, 1048576
    s_cbranch_scc1 L_exit
    s_branch SL_A_m
SL_A_end:
    s_endpgm
SL_C_top:
    s_sleep 2
    buffer_load_dwordx4 v[132:135], v13, s[28:31], s6 offen sc1
    buffer_load_dwordx4 v[136:139], v13, s[28:31], s6 offen offset:1024 sc1
    s_nop 15
    s_nop 7
.p2align 6
SL_C_po:
    buffer_load_dwordx4 v[132:135], v13, s[28:31], s6 offen sc1
    buffer_load_dwordx4 v[136:139], v13, s[28:31], s6 offen offset:1024 sc1
    s_add_u32 s53, s53, 1
    s_cmp_gt_u32 s53, 1048576
    s_cbranch_scc1 L_exit
    s_waitcnt vmcnt(2)
SL_C_pow:
    v_bitop3_b32 v156, v133, v135, s97 bitop3:0x96
    v_bitop3_b32 v157, v137, v139, s97 bitop3:0x96
    v_xor_b32 v148, s42, v133
    v_xor_b32 v149, s42, v137
    v_max_f32 v142, v148, v149
    v_cmp_ne_u64 vcc, 0, v[156:157]
    v_lshlrev_b32 v156, 16, v132
    v_max_f32_dpp v142, v142, v142 row_ror:4 row_mask:0xf bank_mask:0xf
    v_and_b32 v157, 0xffff0000, v132
    v_lshlrev_b32 v158, 16, v134
    v_max_f32_dpp v143, v142, v142 row_ror:8 row_mask:0xf bank_mask:0xf
    v_max_f32_dpp v142, v142, v142 row_ror:8 row_mask:0xf bank_mask:0xf
    s_cbranch_vccnz SL_C_po
    v_and_b32 v159, 0xffff0000, v134
    v_permlane16_swap_b32 v142, v143
    v_max_f32 v144, v142, v143
    v_max_f32 v142, v142, v143
    v_lshlrev_b32 v160, 16, v136
    v_and_b32 v161, 0xffff0000, v136
    v_permlane32_swap_b32 v142, v144
    v_max_f32 v142, v142, v144
    v_sub_f32 v148, v148, v142
    v_sub_f32 v149, v149, v142
    v_exp_f32 v148, v148
    v_exp_f32 v149, v149
    v_lshlrev_b32 v162, 16, v138
    v_pk_mul_f32 v[152:153], v[156:157], v[148:149] op_sel_hi:[1,0]
    v_add_f32 v144, v148, v149
    v_pk_fma_f32 v[152:153], v[160:161], v[148:149], v[152:153] op_sel:[0,1,0]
    v_and_b32 v163, 0xffff0000, v138
    v_pk_mul_f32 v[154:155], v[158:159], v[148:149] op_sel_hi:[1,0]
    v_add_f32_dpp v144, v144, v144 row_ror:4 row_mask:0xf bank_mask:0xf
    v_pk_fma_f32 v[154:155], v[162:163], v[148:149], v[154:155] op_sel:[0,1,0]
    v_permlane32_swap_b32 v152, v153
    v_add_f32_dpp v143, v144, v144 row_ror:8 row_mask:0xf bank_mask:0xf
    v_add_f32_dpp v144, v144, v144 row_ror:8 row_mask:0xf bank_mask:0xf
    v_permlane32_swap_b32 v154, v155
    v_add_f32 v152, v152, v153
    v_add_f32 v154, v154, v155
    v_permlane16_swap_b32 v144, v143
    v_add_f32 v142, v144, v143
    v_permlane16_swap_b32 v152, v154
    v_add_f32 v144, v144, v143
    v_add_f32 v152, v152, v154
    s_nop 0
    v_permlane32_swap_b32 v144, v142
    v_add_f32_dpp v152, v152, v152 row_ror:4 row_mask:0xf bank_mask:0xf
    v_add_f32 v144, v144, v142
    v_rcp_f32 v144, v144
    v_add_f32_dpp v152, v152, v152 row_ror:8 row_mask:0xf bank_mask:0xf
    v_mul_f32 v152, v152, v144
    v_cvt_pk_bf16_f32 v152, v152, v152
    buffer_store_short v152, v14, s[28:31], s6 offen sc1
    s_cmp_lg_u32 s26, 0
    s_cbranch_scc1 SL_G_end
    s_branch SL_G_ba2
SL_G_b1:
SL_G_b2:
    s_barrier
    s_barrier
    s_cmp_lt_u32 s50, 32
    s_cbranch_scc1 SL_C_top
    s_cmp_lg_u32 s26, 0
    s_cbranch_scc1 SL_G_disp
    s_and_b32 s54, s40, 2
    s_cbranch_scc0 SL_G_p8
    s_sleep 10
SL_G_p8:
    s_cmp_eq_u32 s40, 3
    s_cbranch_scc0 SL_G_p9
    s_mov_b32 exec_hi, 0
    global_load_dword v230, v23, s[20:21]
    s_mov_b64 exec, -1
SL_G_p9:
    s_and_b32 s54, s40, 3
    s_cbranch_scc1 SL_G_wf0
SL_G_ba2:
    s_barrier
    s_add_u32 s54, s6, 73728
    s_cmp_lt_u32 s50, 32
    s_cbranch_scc0 SL_G_np
    buffer_load_dwordx4 v[132:135], v13, s[28:31], s54 offen sc1
    buffer_load_dwordx4 v[136:139], v13, s[28:31], s54 offen offset:1024 sc1
SL_G_np:
    s_cmp_lg_u32 s40, 4
    s_cbranch_scc1 SL_G_wf
    buffer_load_dword v230, v24, s[28:31], s54 offen sc1
    s_branch SL_G_fin
SL_G_wf0:
    s_and_b32 s54, s40, 1
    s_cbranch_scc0 SL_G_wf1
    s_mov_b64 exec, 0xff
    v_mov_b32 v21, 0
    buffer_atomic_or v21, v15, s[28:31], 0 offen sc0
    s_mov_b64 exec, -1
SL_G_wf1:
    s_cmp_lt_u32 s47, s49
    s_cbranch_scc0 SL_G_wf2
SL_G_wf:
    buffer_load_dwordx4 v16, s[32:35], s47 offen  lds
    s_add_u32 m0, m0, 4352
    s_add_u32 s47, s47, s48
    s_cmp_lt_u32 s47, s49
    s_cbranch_scc1 SL_G_wf
SL_G_wf2:
SL_G_m:
    s_waitcnt vmcnt(0)
    v_lshlrev_b32 v124, 16, v124
    s_barrier
    s_sub_u32 s54, s40, 1
    s_cmp_lt_u32 s54, 2
    s_cbranch_scc0 SL_G_tr
    buffer_load_dwordx4 v[96:99], v3, s[28:31], s46 offen sc1
SL_G_tr:
    ds_read_b64_tr_b16 v[32:33], v7 offset:0
    ds_read_b64_tr_b16 v[34:35], v7 offset:256
    ds_read_b64_tr_b16 v[36:37], v8 offset:0
    ds_read_b64_tr_b16 v[38:39], v8 offset:256
    v_mov_b64 v[152:153], 0
    v_mov_b64 v[154:155], 0
    v_mov_b32 v156, v5
    v_mov_b32 v157, v5
    v_mov_b32 v158, v5
    v_mov_b32 v159, v5
    ds_read_b64_tr_b16 v[40:41], v7 offset:2176
    ds_read_b64_tr_b16 v[42:43], v7 offset:2432
    ds_read_b64_tr_b16 v[44:45], v8 offset:2176
    ds_read_b64_tr_b16 v[46:47], v8 offset:2432
    ds_read_b64_tr_b16 v[48:49], v7 offset:4352
    ds_read_b64_tr_b16 v[50:51], v7 offset:4608
    ds_read_b64_tr_b16 v[52:53], v8 offset:4352
    ds_read_b64_tr_b16 v[54:55], v8 offset:4608
    ds_read_b64_tr_b16 v[56:57], v7 offset:6528
    ds_read_b64_tr_b16 v[58:59], v7 offset:6784
    ds_read_b64_tr_b16 v[60:61], v8 offset:6528
    ds_read_b64_tr_b16 v[62:63], v8 offset:6784
    s_waitcnt lgkmcnt(12)
    v_smfmac_f32_16x16x64_bf16 v[152:155], v[156:159], v[32:39], v4
    ds_read_b64_tr_b16 v[64:65], v7 offset:8704
    ds_read_b64_tr_b16 v[66:67], v7 offset:8960
    ds_read_b64_tr_b16 v[68:69], v8 offset:8704
    ds_read_b64_tr_b16 v[70:71], v8 offset:8960
    s_waitcnt lgkmcnt(12)
    v_smfmac_f32_16x16x64_bf16 v[152:155], v[156:159], v[40:47], v4
    ds_read_b64_tr_b16 v[72:73], v7 offset:10880
    ds_read_b64_tr_b16 v[74:75], v7 offset:11136
    ds_read_b64_tr_b16 v[76:77], v8 offset:10880
    ds_read_b64_tr_b16 v[78:79], v8 offset:11136
    s_waitcnt lgkmcnt(12)
    v_smfmac_f32_16x16x64_bf16 v[152:155], v[156:159], v[48:55], v4
    ds_read_b64_tr_b16 v[80:81], v7 offset:13056
    ds_read_b64_tr_b16 v[82:83], v7 offset:13312
    ds_read_b64_tr_b16 v[84:85], v8 offset:13056
    ds_read_b64_tr_b16 v[86:87], v8 offset:13312
    s_waitcnt lgkmcnt(12)
    v_smfmac_f32_16x16x64_bf16 v[152:155], v[156:159], v[56:63], v4
    ds_read_b64_tr_b16 v[88:89], v7 offset:15232
    ds_read_b64_tr_b16 v[90:91], v7 offset:15488
    ds_read_b64_tr_b16 v[92:93], v8 offset:15232
    ds_read_b64_tr_b16 v[94:95], v8 offset:15488
    s_waitcnt lgkmcnt(12)
    v_smfmac_f32_16x16x64_bf16 v[152:155], v[156:159], v[64:71], v4
    s_cmp_eq_u32 s40, 1
    s_cbranch_scc1 SL_O_poll
SL_G_tr2:
    s_waitcnt lgkmcnt(8)
    v_smfmac_f32_16x16x64_bf16 v[152:155], v[156:159], v[72:79], v4
    s_waitcnt lgkmcnt(4)
    v_smfmac_f32_16x16x64_bf16 v[152:155], v[156:159], v[80:87], v4
    s_cmp_eq_u32 s40, 2
    s_cselect_b32 s54, s41, 99
    s_cmp_lt_u32 s54, 14
    s_nop 4
    v_add_f32 v114, v152, v153
    s_cbranch_scc1 SL_X_poll
SL_G_disp:
    s_cmp_eq_u32 s40, 1
    s_cbranch_scc1 SL_O_go
    s_cmp_eq_u32 s40, 3
    s_cbranch_scc1 SL_H_go
    s_cmp_eq_u32 s40, 2
    s_cbranch_scc0 SL_G_d2
    s_cmp_lt_u32 s41, 14
    s_cbranch_scc0 SL_G_fin
    s_cmp_lg_u32 s26, 0
    s_cbranch_scc0 SL_X_poll0
    s_branch SL_X_poll0
SPC1:
    s_setpc_b64 s[88:89]
SL_G_d2:
    s_cmp_lg_u32 s26, 0
    s_cbranch_scc1 SL_G_end
    s_cmp_eq_u32 s40, 0
    s_cbranch_scc0 SL_G_fin
    v_mov_b32 v17, 68608
SL_Q_gate:
    buffer_load_dword v18, v17, s[28:31], s6 offen sc1
    s_add_u32 s53, s53, 1
    s_cmp_gt_u32 s53, 1048576
    s_cbranch_scc1 L_exit
    s_sleep 2
    s_waitcnt vmcnt(0)
    v_cmp_eq_u32 vcc, s52, v18
    s_cbranch_vccnz SL_Q_gate
SL_X_poll0:
    buffer_load_dwordx4 v[96:99], v3, s[28:31], s46 offen sc1
    s_nop 15
    s_nop 7
.p2align 6
SL_X_poll:
    buffer_load_dwordx4 v[96:99], v3, s[28:31], s46 offen sc1
    s_sub_u32 s45, s45, 1
    s_cbranch_scc1 SL_X_poll_esc
SL_X_poll_z:
    v_mov_b64 v[108:109], 0
    v_mov_b64 v[110:111], 0
    s_waitcnt vmcnt(1) lgkmcnt(0)
SL_X_x:
    v_dot2_f32_bf16 v113, v96, v96, 0
    v_dot2_f32_bf16 v113, v97, v97, v113
    v_dot2_f32_bf16 v113, v98, v98, v113
    v_dot2_f32_bf16 v113, v99, v99, v113
    v_smfmac_f32_16x16x64_bf16 v[108:111], v[96:99], v[32:39], v4
    v_dot2_f32_bf16 v112, v96, v5, 0
    v_dot2_f32_bf16 v112, v97, v5, v112
    v_cmp_class_f32 vcc, v113, s27
    v_dot2_f32_bf16 v112, v98, v5, v112
    v_dot2_f32_bf16 v112, v99, v5, v112
    v_mov_b32_dpp v104, v96 row_shl:2 row_mask:0xf bank_mask:0xf
    v_mov_b32_dpp v105, v97 row_shl:2 row_mask:0xf bank_mask:0xf
    v_mov_b32_dpp v106, v98 row_shl:2 row_mask:0xf bank_mask:0xf
    v_mov_b32_dpp v107, v99 row_shl:2 row_mask:0xf bank_mask:0xf
    s_cbranch_vccnz SL_X_poll
    v_permlane32_swap_b32 v112, v113
    v_add_f32 v112, v112, v113
    v_smfmac_f32_16x16x64_bf16 v[108:111], v[104:107], v[40:47], v4
    v_mov_b32_dpp v100, v96 row_shl:4 row_mask:0xf bank_mask:0xf
    v_add_f32_dpp v112, v112, v112 row_ror:8 row_mask:0xf bank_mask:0xf
    v_mov_b32_dpp v101, v97 row_shl:4 row_mask:0xf bank_mask:0xf
    v_mov_b32_dpp v102, v98 row_shl:4 row_mask:0xf bank_mask:0xf
    v_add_f32_dpp v112, v112, v112 row_ror:4 row_mask:0xf bank_mask:0xf
    v_mov_b32_dpp v103, v99 row_shl:4 row_mask:0xf bank_mask:0xf
    v_mov_b32_dpp v104, v96 row_shl:6 row_mask:0xf bank_mask:0xf
    v_add_f32_dpp v112, v112, v112 row_ror:2 row_mask:0xf bank_mask:0xf
    v_smfmac_f32_16x16x64_bf16 v[108:111], v[100:103], v[48:55], v4
    v_mov_b32_dpp v105, v97 row_shl:6 row_mask:0xf bank_mask:0xf
    v_add_f32_dpp v112, v112, v112 row_ror:1 row_mask:0xf bank_mask:0xf
    v_mov_b32_dpp v106, v98 row_shl:6 row_mask:0xf bank_mask:0xf
    v_mov_b32_dpp v107, v99 row_shl:6 row_mask:0xf bank_mask:0xf
    v_add_f32_dpp v112, v112, v112 row_bcast:15 row_mask:0xa bank_mask:0xf
    v_mov_b32_dpp v100, v96 row_shl:8 row_mask:0xf bank_mask:0xf
    v_smfmac_f32_16x16x64_bf16 v[108:111], v[104:107], v[56:63], v4
    v_fma_f32 v112, v112, v140, v141
    v_mov_b32_dpp v101, v97 row_shl:8 row_mask:0xf bank_mask:0xf
    v_readlane_b32 s98, v112, 16
    v_readlane_b32 s99, v112, 48
    v_mov_b32_dpp v102, v98 row_shl:8 row_mask:0xf bank_mask:0xf
    v_mov_b32_dpp v103, v99 row_shl:8 row_mask:0xf bank_mask:0xf
    v_mov_b32_dpp v104, v96 row_shl:10 row_mask:0xf bank_mask:0xf
    v_mov_b32_dpp v105, v97 row_shl:10 row_mask:0xf bank_mask:0xf
    v_smfmac_f32_16x16x64_bf16 v[108:111], v[100:103], v[64:71], v4
    v_mov_b32_dpp v106, v98 row_shl:10 row_mask:0xf bank_mask:0xf
    v_mov_b32_dpp v107, v99 row_shl:10 row_mask:0xf bank_mask:0xf
    v_mov_b32_dpp v100, v96 row_shl:12 row_mask:0xf bank_mask:0xf
    v_mov_b32_dpp v101, v97 row_shl:12 row_mask:0xf bank_mask:0xf
    v_smfmac_f32_16x16x64_bf16 v[108:111], v[104:107], v[72:79], v4
    v_mov_b32_dpp v102, v98 row_shl:12 row_mask:0xf bank_mask:0xf
    v_mov_b32_dpp v103, v99 row_shl:12 row_mask:0xf bank_mask:0xf
    v_mov_b32 v117, s98
    s_cmp_eq_u32 s40, 0
    v_smfmac_f32_16x16x64_bf16 v[108:111], v[100:103], v[80:87], v4
    s_cbranch_scc1 SL_X_eq
    v_fma_f32 v118, -v117, v117, s99
    v_max_f32 v119, s96, v118
    v_rsq_f32 v119, v119
    v_mul_f32 v117, v117, v114
    v_mul_f32 v117, v117, v119
    v_mul_f32 v120, 0xbfb8aa3b, v119
    v_mul_f32 v121, 0x3fb8aa3b, v117
    v_add_f32 v116, v108, v109
    v_fma_f32 v120, v116, v120, v121
    v_exp_f32 v120, v120
    v_fma_f32 v116, v116, v119, -v117
    v_add_f32 v120, 1.0, v120
    v_rcp_f32 v120, v120
    s_nop 0
    v_mul_f32 v116, v116, v120
    v_cvt_pk_bf16_f32 v116, v116, v116
    buffer_store_short v116, v6, s[28:31], s6 offen sc1
    s_branch SL_G_fin
SL_X_eq:
    v_fma_f32 v118, -v117, v117, s99
    v_max_f32 v119, s96, v118
    v_rsq_f32 v119, v119
    v_mul_f32 v117, v117, v114
    v_mul_f32 v117, v117, v119
    s_nop 1
    v_add_f32 v116, v108, v109
    v_fma_f32 v116, v116, v119, -v117
    v_cvt_pk_bf16_f32 v117, v116, v116
    buffer_store_short v117, v6, s[28:31], s6 offen sc1
    s_barrier
    s_branch SL_G_next
SL_H_go:
    s_mov_b64 exec, 0xff
    s_branch SL_H_rd2
SPC2:
    s_setpc_b64 s[88:89]
SL_H_rd:
    v_mov_b32 v21, 0
    buffer_atomic_or v21, v15, s[28:31], 0 offen sc0
    s_add_u32 s53, s53, 1
    s_cmp_gt_u32 s53, 1048576
    s_cbranch_scc1 L_exit
    s_waitcnt vmcnt(0)
SL_H_rd2:
    v_cmp_ne_u32 vcc, s42, v21
    s_cbranch_vccnz SL_H_rd
    s_mov_b64 exec, -1
    s_add_u32 s51, s6, 69632
SL_H_gate:
    buffer_load_ushort v115, v11, s[28:31], s51 offen sc1
    s_add_u32 s53, s53, 1
    s_cmp_gt_u32 s53, 1048576
    s_cbranch_scc1 L_exit
    s_sleep 1
    s_waitcnt vmcnt(0)
    v_cmp_eq_u32 vcc, 0xffa5, v115
    s_cbranch_vccnz SL_H_gate
    v_lshlrev_b32 v124, 16, v115
SL_H_poll0:
    buffer_load_dwordx4 v[96:99], v3, s[28:31], s46 offen sc1
    s_nop 15
    s_nop 7
.p2align 6
SL_H_poll:
    buffer_load_dwordx4 v[96:99], v3, s[28:31], s46 offen sc1
    s_sub_u32 s45, s45, 1
    s_cbranch_scc1 SL_H_poll_esc
SL_H_poll_z:
    v_mov_b64 v[108:109], 0
    v_mov_b64 v[110:111], 0
    s_waitcnt vmcnt(1) lgkmcnt(0)
SL_H_x:
    v_dot2_f32_bf16 v113, v96, v96, 0
    v_dot2_f32_bf16 v113, v97, v97, v113
    v_dot2_f32_bf16 v113, v98, v98, v113
    v_dot2_f32_bf16 v113, v99, v99, v113
    v_smfmac_f32_16x16x64_bf16 v[108:111], v[96:99], v[32:39], v4
    v_mov_b32_dpp v104, v96 row_shl:2 row_mask:0xf bank_mask:0xf
    v_mov_b32_dpp v105, v97 row_shl:2 row_mask:0xf bank_mask:0xf
    v_cmp_class_f32 vcc, v113, s27
    v_mov_b32_dpp v106, v98 row_shl:2 row_mask:0xf bank_mask:0xf
    v_mov_b32_dpp v107, v99 row_shl:2 row_mask:0xf bank_mask:0xf
    v_mov_b32_dpp v100, v96 row_shl:4 row_mask:0xf bank_mask:0xf
    v_mov_b32_dpp v101, v97 row_shl:4 row_mask:0xf bank_mask:0xf
    v_mov_b32_dpp v102, v98 row_shl:4 row_mask:0xf bank_mask:0xf
    v_mov_b32_dpp v103, v99 row_shl:4 row_mask:0xf bank_mask:0xf
    s_cbranch_vccnz SL_H_poll
    v_smfmac_f32_16x16x64_bf16 v[108:111], v[104:107], v[40:47], v4
    v_mov_b32_dpp v104, v96 row_shl:6 row_mask:0xf bank_mask:0xf
    v_mov_b32_dpp v105, v97 row_shl:6 row_mask:0xf bank_mask:0xf
    v_mov_b32_dpp v106, v98 row_shl:6 row_mask:0xf bank_mask:0xf
    v_mov_b32_dpp v107, v99 row_shl:6 row_mask:0xf bank_mask:0xf
    v_smfmac_f32_16x16x64_bf16 v[108:111], v[100:103], v[48:55], v4
    s_nop 0
    v_smfmac_f32_16x16x64_bf16 v[108:111], v[104:107], v[56:63], v4
    s_cmp_lg_u32 s26, 0
    s_nop 6
    v_add_f32 v116, v108, v109
    buffer_atomic_swap v116, v6, s[28:31], s44 offen
SL_H_sk:
    s_cbranch_scc0 SL_R_go
    s_mov_b64 exec, 1
    global_atomic_add v146, v125, v147, s[28:29] offset:64 sc0
    s_mov_b64 exec, -1
SL_Z_poll:
    global_atomic_or_x2 v[122:123], v125, v[126:127], s[28:29] sc0
    s_add_u32 s53, s53, 1
    s_cmp_gt_u32 s53, 1048576
    s_cbranch_scc1 L_exit
    s_waitcnt vmcnt(0)
SL_Z_x:
    v_readfirstlane_b32 s51, v146
    v_cmp_eq_u32 vcc, s52, v122
    v_cmp_eq_u32 s[54:55], s52, v123
    v_add_f32_dpp v116, v122, v122 row_ror:8 row_mask:0xf bank_mask:0xf
    v_add_f32_dpp v117, v123, v123 row_ror:8 row_mask:0xf bank_mask:0xf
    s_cmp_lg_u32 s51, 4289068972
    s_cbranch_scc1 SL_Z_no
SL_Z_y:
    v_permlane32_swap_b32 v116, v117
    v_add_f32 v116, v116, v117
    v_add_f32 v117, v116, v124
    s_or_b64 vcc, vcc, s[54:55]
    s_cbranch_scc1 SL_Z_poll
    v_permlane16_swap_b32 v117, v116
    v_add_f32 v116, v116, v117
    v_cvt_pk_bf16_f32 v116, v116, v116
    buffer_store_short v116, v10, s[36:39], 0 offen
    s_branch SL_Z_end
SL_Z_no:
    s_branch SL_Z_end
SL_O_go:
SL_O_poll0:
    buffer_load_dwordx4 v[96:99], v3, s[28:31], s46 offen sc1
    s_nop 15
    s_nop 7
.p2align 6
SL_O_poll:
    buffer_load_dwordx4 v[96:99], v3, s[28:31], s46 offen sc1
    s_sub_u32 s45, s45, 1
    s_cbranch_scc1 SL_O_poll_esc
SL_O_poll_z:
    v_mov_b64 v[108:109], 0
    v_mov_b64 v[110:111], 0
    s_waitcnt vmcnt(1) lgkmcnt(0)
SL_O_x:
    v_dot2_f32_bf16 v113, v96, v96, 0
    v_dot2_f32_bf16 v113, v97, v97, v113
    v_dot2_f32_bf16 v113, v98, v98, v113
    v_dot2_f32_bf16 v113, v99, v99, v113
    v_smfmac_f32_16x16x64_bf16 v[108:111], v[96:99], v[32:39], v4
    v_mov_b32_dpp v104, v96 row_shl:2 row_mask:0xf bank_mask:0xf
    v_mov_b32_dpp v105, v97 row_shl:2 row_mask:0xf bank_mask:0xf
    v_cmp_class_f32 vcc, v113, s27
    v_mov_b32_dpp v106, v98 row_shl:2 row_mask:0xf bank_mask:0xf
    v_mov_b32_dpp v107, v99 row_shl:2 row_mask:0xf bank_mask:0xf
    v_mov_b32_dpp v100, v96 row_shl:4 row_mask:0xf bank_mask:0xf
    v_mov_b32_dpp v101, v97 row_shl:4 row_mask:0xf bank_mask:0xf
    v_mov_b32_dpp v102, v98 row_shl:4 row_mask:0xf bank_mask:0xf
    v_mov_b32_dpp v103, v99 row_shl:4 row_mask:0xf bank_mask:0xf
    s_cbranch_vccnz SL_O_poll
    v_smfmac_f32_16x16x64_bf16 v[108:111], v[104:107], v[40:47], v4
    v_mov_b32_dpp v104, v96 row_shl:6 row_mask:0xf bank_mask:0xf
    v_mov_b32_dpp v105, v97 row_shl:6 row_mask:0xf bank_mask:0xf
    v_mov_b32_dpp v106, v98 row_shl:6 row_mask:0xf bank_mask:0xf
    v_mov_b32_dpp v107, v99 row_shl:6 row_mask:0xf bank_mask:0xf
    v_smfmac_f32_16x16x64_bf16 v[108:111], v[100:103], v[48:55], v4
    v_mov_b32_dpp v100, v96 row_shl:8 row_mask:0xf bank_mask:0xf
    v_mov_b32_dpp v101, v97 row_shl:8 row_mask:0xf bank_mask:0xf
    v_mov_b32_dpp v102, v98 row_shl:8 row_mask:0xf bank_mask:0xf
    v_mov_b32_dpp v103, v99 row_shl:8 row_mask:0xf bank_mask:0xf
    v_smfmac_f32_16x16x64_bf16 v[108:111], v[104:107], v[56:63], v4
    v_mov_b32_dpp v104, v96 row_shl:10 row_mask:0xf bank_mask:0xf
    v_mov_b32_dpp v105, v97 row_shl:10 row_mask:0xf bank_mask:0xf
    v_mov_b32_dpp v106, v98 row_shl:10 row_mask:0xf bank_mask:0xf
    v_mov_b32_dpp v107, v99 row_shl:10 row_mask:0xf bank_mask:0xf
    v_smfmac_f32_16x16x64_bf16 v[108:111], v[100:103], v[64:71], v4
    v_mov_b32_dpp v100, v96 row_shl:12 row_mask:0xf bank_mask:0xf
    v_mov_b32_dpp v101, v97 row_shl:12 row_mask:0xf bank_mask:0xf
    v_mov_b32_dpp v102, v98 row_shl:12 row_mask:0xf bank_mask:0xf
    v_mov_b32_dpp v103, v99 row_shl:12 row_mask:0xf bank_mask:0xf
    v_smfmac_f32_16x16x64_bf16 v[108:111], v[104:107], v[72:79], v4
    v_mov_b32_dpp v104, v96 row_shl:14 row_mask:0xf bank_mask:0xf
    v_mov_b32_dpp v105, v97 row_shl:14 row_mask:0xf bank_mask:0xf
    v_mov_b32_dpp v106, v98 row_shl:14 row_mask:0xf bank_mask:0xf
    v_mov_b32_dpp v107, v99 row_shl:14 row_mask:0xf bank_mask:0xf
    v_smfmac_f32_16x16x64_bf16 v[108:111], v[100:103], v[80:87], v4
    s_nop 0
    v_smfmac_f32_16x16x64_bf16 v[108:111], v[104:107], v[88:95], v4
    s_nop 7
    v_add_f32 v116, v108, v109
    buffer_atomic_swap v116, v6, s[28:31], s44 offen
SL_O_sk:
SL_R_go:
    s_barrier
    v_cmp_ne_u32 vcc, s42, v21
    v_add_u32 v125, s44, v9
    v_mov_b64 v[126:127], 0
    s_and_b32 s54, vcc_lo, 0xff
    s_cbranch_scc1 SL_R_rd
SL_R_rdok:
    s_sleep 3
    global_atomic_or_x2 v[122:123], v125, v[126:127], s[28:29] sc0
    s_nop 15
    s_nop 15
    s_nop 15
    s_nop 11
    s_branch SL_R_p1
SPC3:
    s_setpc_b64 s[88:89]
.p2align 6
SL_R_poll:
SL_R_p1:
    global_atomic_or_x2 v[122:123], v125, v[126:127], s[28:29] sc0
    s_add_u32 s53, s53, 1
    s_cmp_gt_u32 s53, 1048576
    s_cbranch_scc1 L_exit
    s_waitcnt vmcnt(1)
SL_R_x:
    v_cmp_eq_u32 vcc, s52, v122
    v_cmp_eq_u32 s[54:55], s52, v123
    v_add_f32_dpp v116, v122, v122 row_ror:8 row_mask:0xf bank_mask:0xf
    v_add_f32_dpp v117, v123, v123 row_ror:8 row_mask:0xf bank_mask:0xf
    s_nop 1
    v_permlane32_swap_b32 v116, v117
    v_add_f32 v116, v116, v117
    v_add_f32 v117, v116, v124
    s_or_b64 vcc, vcc, s[54:55]
    s_cbranch_scc1 SL_R_poll
    v_permlane16_swap_b32 v117, v116
    v_add_f32 v116, v116, v117
    v_cvt_pk_bf16_f32 v116, v116, v116
    buffer_store_short v116, v10, s[36:39], s56 offen sc1
    s_branch SL_G_fin
SL_Z_end:
SL_G_end:
SL_G_end2:
    s_endpgm
SL_G_fin:
    s_cmp_lg_u32 s26, 0
    s_cbranch_scc1 SL_G_end
    s_barrier
    s_cmp_eq_u32 s40, 1
    s_cselect_b32 s54, 3, s3
    s_cmp_eq_u32 s54, 3
    s_cbranch_scc0 SL_G_next
SL_G_x2:
    buffer_load_ushort v115, v11, s[28:31], s57 offen sc1
    s_add_u32 s53, s53, 1
    s_cmp_gt_u32 s53, 1048576
    s_cbranch_scc1 L_exit
    s_sleep 1
    s_waitcnt vmcnt(0)
    v_cmp_eq_u32 vcc, 0xffa5, v115
    s_cbranch_vccnz SL_G_x2
    v_lshlrev_b32 v124, 16, v115
SL_G_next:
    s_cmp_eq_u32 s3, 3
    s_cbranch_scc0 SL_G_nb
    v_lshlrev_b32 v27, 4, v0
    v_add_u32 v26, 145408, v27
    v_add_u32 v27, 144384, v27
    s_mov_b32 s27, 3
SL_Q_poll0:
    buffer_load_dwordx4 v[128:131], v26, s[28:31], s6 offen sc1
    s_nop 15
    s_nop 7
    buffer_load_dwordx4 v[128:131], v26, s[28:31], s6 offen sc1
.p2align 7
SL_Q_poll:
    s_waitcnt vmcnt(1) lgkmcnt(0)
    v_dot2_f32_bf16 v113, v128, v128, 0
    v_dot2_f32_bf16 v113, v129, v129, v113
    v_dot2_f32_bf16 v113, v130, v130, v113
    v_dot2_f32_bf16 v113, v131, v131, v113
    ds_write_b128 v27, v[128:131]
    buffer_load_dwordx4 v[128:131], v26, s[28:31], s6 offen sc1
    s_sub_u32 s45, s45, 1
    s_cbranch_scc1 SL_Q_poll_esc
    v_cmp_class_f32 vcc, v113, s27
    s_cbranch_vccnz SL_Q_poll
    s_waitcnt lgkmcnt(0)
SL_G_nb:
    s_barrier
    s_mov_b32 s27, 3
    s_mov_b32 s26, 1
    s_add_u32 s6, s6, 73728
    s_add_u32 s44, s44, 0x10000
    s_add_u32 s46, s46, 73728
    s_add_u32 s56, s56, 73728
    s_cmp_eq_u32 s40, 3
    s_cbranch_scc0 SL_G_e2
    s_mov_b32 s36, s24
    s_mov_b32 s37, s25
    s_mov_b32 s38, 896
    v_add_u32 v125, s44, v9
    v_mov_b32 v147, 1
    s_or_b32 s54, s41, s4
    s_cbranch_scc1 SL_G_e2
    v_mov_b32 v17, 0
    v_mov_b32 v18, s42
    s_mov_b64 exec, 1
    buffer_store_dword v18, v17, s[28:31], 0 offen sc1
    s_mov_b64 exec, -1
SL_G_e2:
    s_cmp_lt_u32 s50, 32
    s_cbranch_scc1 SL_G_b1
    s_and_b32 s54, s40, 3
    s_cbranch_scc1 SL_G_b1
    s_branch SL_G_end2
SL_X_poll_esc:
    s_movk_i32 s45, 0xfff
    s_add_u32 s53, s53, 0x1000
    s_cmp_gt_u32 s53, 1048576
    s_cbranch_scc1 L_exit
    s_waitcnt vmcnt(0) lgkmcnt(0)
    s_mov_b64 s[54:55], 0
    v_and_b32 v120, 0xffff, v96
    v_cmp_eq_u32 vcc, 0xffa5, v120
    s_or_b64 s[54:55], s[54:55], vcc
    v_lshrrev_b32 v120, 16, v96
    v_cmp_eq_u32 vcc, 0xffa5, v120
    s_or_b64 s[54:55], s[54:55], vcc
    v_and_b32 v120, 0xffff, v97
    v_cmp_eq_u32 vcc, 0xffa5, v120
    s_or_b64 s[54:55], s[54:55], vcc
    v_lshrrev_b32 v120, 16, v97
    v_cmp_eq_u32 vcc, 0xffa5, v120
    s_or_b64 s[54:55], s[54:55], vcc
    v_and_b32 v120, 0xffff, v98
    v_cmp_eq_u32 vcc, 0xffa5, v120
    s_or_b64 s[54:55], s[54:55], vcc
    v_lshrrev_b32 v120, 16, v98
    v_cmp_eq_u32 vcc, 0xffa5, v120
    s_or_b64 s[54:55], s[54:55], vcc
    v_and_b32 v120, 0xffff, v99
    v_cmp_eq_u32 vcc, 0xffa5, v120
    s_or_b64 s[54:55], s[54:55], vcc
    v_lshrrev_b32 v120, 16, v99
    v_cmp_eq_u32 vcc, 0xffa5, v120
    s_or_b64 s[54:55], s[54:55], vcc
    s_cbranch_scc1 SL_X_poll0
    s_mov_b32 s27, 0
    s_branch SL_X_poll_z
SL_H_poll_esc:
    s_movk_i32 s45, 0xfff
    s_add_u32 s53, s53, 0x1000
    s_cmp_gt_u32 s53, 1048576
    s_cbranch_scc1 L_exit
    s_waitcnt vmcnt(0) lgkmcnt(0)
    s_mov_b64 s[54:55], 0
    v_and_b32 v117, 0xffff, v96
    v_cmp_eq_u32 vcc, 0xffa5, v117
    s_or_b64 s[54:55], s[54:55], vcc
    v_lshrrev_b32 v117, 16, v96
    v_cmp_eq_u32 vcc, 0xffa5, v117
    s_or_b64 s[54:55], s[54:55], vcc
    v_and_b32 v117, 0xffff, v97
    v_cmp_eq_u32 vcc, 0xffa5, v117
    s_or_b64 s[54:55], s[54:55], vcc
    v_lshrrev_b32 v117, 16, v97
    v_cmp_eq_u32 vcc, 0xffa5, v117
    s_or_b64 s[54:55], s[54:55], vcc
    v_and_b32 v117, 0xffff, v98
    v_cmp_eq_u32 vcc, 0xffa5, v117
    s_or_b64 s[54:55], s[54:55], vcc
    v_lshrrev_b32 v117, 16, v98
    v_cmp_eq_u32 vcc, 0xffa5, v117
    s_or_b64 s[54:55], s[54:55], vcc
    v_and_b32 v117, 0xffff, v99
    v_cmp_eq_u32 vcc, 0xffa5, v117
    s_or_b64 s[54:55], s[54:55], vcc
    v_lshrrev_b32 v117, 16, v99
    v_cmp_eq_u32 vcc, 0xffa5, v117
    s_or_b64 s[54:55], s[54:55], vcc
    s_cbranch_scc1 SL_H_poll0
    s_mov_b32 s27, 0
    s_branch SL_H_poll_z
SL_O_poll_esc:
    s_movk_i32 s45, 0xfff
    s_add_u32 s53, s53, 0x1000
    s_cmp_gt_u32 s53, 1048576
    s_cbranch_scc1 L_exit
    s_waitcnt vmcnt(0) lgkmcnt(0)
    s_mov_b64 s[54:55], 0
    v_and_b32 v117, 0xffff, v96
    v_cmp_eq_u32 vcc, 0xffa5, v117
    s_or_b64 s[54:55], s[54:55], vcc
    v_lshrrev_b32 v117, 16, v96
    v_cmp_eq_u32 vcc, 0xffa5, v117
    s_or_b64 s[54:55], s[54:55], vcc
    v_and_b32 v117, 0xffff, v97
    v_cmp_eq_u32 vcc, 0xffa5, v117
    s_or_b64 s[54:55], s[54:55], vcc
    v_lshrrev_b32 v117, 16, v97
    v_cmp_eq_u32 vcc, 0xffa5, v117
    s_or_b64 s[54:55], s[54:55], vcc
    v_and_b32 v117, 0xffff, v98
    v_cmp_eq_u32 vcc, 0xffa5, v117
    s_or_b64 s[54:55], s[54:55], vcc
    v_lshrrev_b32 v117, 16, v98
    v_cmp_eq_u32 vcc, 0xffa5, v117
    s_or_b64 s[54:55], s[54:55], vcc
    v_and_b32 v117, 0xffff, v99
    v_cmp_eq_u32 vcc, 0xffa5, v117
    s_or_b64 s[54:55], s[54:55], vcc
    v_lshrrev_b32 v117, 16, v99
    v_cmp_eq_u32 vcc, 0xffa5, v117
    s_or_b64 s[54:55], s[54:55], vcc
    s_cbranch_scc1 SL_O_poll0
    s_mov_b32 s27, 0
    s_branch SL_O_poll_z
SL_R_rd:
    s_mov_b64 exec, 0xff
SL_R_rd1:
    v_mov_b32 v21, 0
    buffer_atomic_or v21, v15, s[28:31], 0 offen sc0
    s_add_u32 s53, s53, 1
    s_cmp_gt_u32 s53, 1048576
    s_cbranch_scc1 L_exit
    s_waitcnt vmcnt(0)
    v_cmp_ne_u32 vcc, s42, v21
    s_cbranch_vccnz SL_R_rd1
    s_mov_b64 exec, -1
    s_branch SL_R_rdok
SL_Q_poll_esc:
    s_movk_i32 s45, 0xfff
    s_add_u32 s53, s53, 0x1000
    s_cmp_gt_u32 s53, 1048576
    s_cbranch_scc1 L_exit
    s_waitcnt vmcnt(0) lgkmcnt(0)
    s_mov_b64 s[54:55], 0
    v_and_b32 v116, 0xffff, v128
    v_cmp_eq_u32 vcc, 0xffa5, v116
    s_or_b64 s[54:55], s[54:55], vcc
    v_lshrrev_b32 v116, 16, v128
    v_cmp_eq_u32 vcc, 0xffa5, v116
    s_or_b64 s[54:55], s[54:55], vcc
    v_and_b32 v116, 0xffff, v129
    v_cmp_eq_u32 vcc, 0xffa5, v116
    s_or_b64 s[54:55], s[54:55], vcc
    v_lshrrev_b32 v116, 16, v129
    v_cmp_eq_u32 vcc, 0xffa5, v116
    s_or_b64 s[54:55], s[54:55], vcc
    v_and_b32 v116, 0xffff, v130
    v_cmp_eq_u32 vcc, 0xffa5, v116
    s_or_b64 s[54:55], s[54:55], vcc
    v_lshrrev_b32 v116, 16, v130
    v_cmp_eq_u32 vcc, 0xffa5, v116
    s_or_b64 s[54:55], s[54:55], vcc
    v_and_b32 v116, 0xffff, v131
    v_cmp_eq_u32 vcc, 0xffa5, v116
    s_or_b64 s[54:55], s[54:55], vcc
    v_lshrrev_b32 v116, 16, v131
    v_cmp_eq_u32 vcc, 0xffa5, v116
    s_or_b64 s[54:55], s[54:55], vcc
    s_cbranch_scc1 SL_Q_poll0
    s_mov_b32 s27, 0
    s_branch SL_Q_poll
L_code_end:
.section .rodata,"a"
.p2align 6
.amdhsa_kernel interleave_layers__sliding_block_cached__dense_activation_silu__decode_kernel
  .amdhsa_next_free_vgpr 232
  .amdhsa_next_free_sgpr 102
  .amdhsa_accum_offset 232
  .amdhsa_group_segment_fixed_size 0
  .amdhsa_kernarg_size 88
  .amdhsa_user_sgpr_count 2
  .amdhsa_user_sgpr_kernarg_segment_ptr 1
  .amdhsa_system_sgpr_workgroup_id_x 1
.end_amdhsa_kernel
```
